```python
import torch

def _softmax(x, axis=-1):
    return torch.softmax(x, dim=axis)
def _gelu(x):
    return torch.nn.functional.gelu(x, approximate="tanh")
def _silu(x):
    return torch.nn.functional.silu(x)
def _sigmoid(x):
    return torch.sigmoid(x)
def _layernorm(x, axis=-1, eps=1e-5):
    m = x.mean(dim=axis, keepdim=True)
    v = x.var(dim=axis, keepdim=True, unbiased=False)
    return (x - m) / torch.sqrt(v + eps)
def _scatter_add(tgt, idx, src, axis=0):
    return tgt.clone().index_add_(axis, idx, src)
def _segment_sum(src, seg, n):
    out = torch.zeros((n,) + src.shape[1:], dtype=src.dtype)
    return out.index_add_(0, seg, src)
def _pad(x, pw):
    flat = tuple(v for pair in reversed(pw) for v in pair)
    return torch.nn.functional.pad(x, flat)

kernel_name = 'gated_mix__spectral_fnet__softmax_full_mha__prompt'

def setup_inputs():

    _w = (lambda a: (lambda t: t.to(torch.bfloat16) if t.is_floating_point() else t)(torch.as_tensor(a)))
    def _A_setup():
        B, S, D = 1, 2048, 1024
        ns = torch.arange(S)[:, None] * torch.arange(S)[None, :]
        nd = torch.arange(D)[:, None] * torch.arange(D)[None, :]
        Ws_re = torch.cos(-2.0 * torch.pi * ns / S).to(float)
        Ws_im = torch.sin(-2.0 * torch.pi * ns / S).to(float)
        Wd_re = torch.cos(-2.0 * torch.pi * nd / D).to(float)
        Wd_im = torch.sin(-2.0 * torch.pi * nd / D).to(float)
        return {
            "x": _w((lambda *s: torch.randn(*s, dtype=torch.bfloat16) * 0.05)(B, S, D)),
            "dft_seq_re": _w(Ws_re),
            "dft_seq_im": _w(Ws_im),
            "dft_hid_re": _w(Wd_re),
            "dft_hid_im": _w(Wd_im),
        }
    _A_in = _A_setup()

    def _B_setup():
        B, S, D = 1, 2048, 1024
        return {
            "x": _w((lambda *s: torch.randn(*s, dtype=torch.bfloat16) * 0.05)(B, S, D)),
            "wqkv": _w((lambda *s: torch.randn(*s, dtype=torch.bfloat16) * 1.6)(D, 3 * D)),
            "wo": _w((lambda *s: torch.randn(*s, dtype=torch.bfloat16) * 0.2)(D, D)),
        }
    _B_in = _B_setup()

    return {
        "A_x": _A_in["x"],
        "A_dft_seq_re": _A_in["dft_seq_re"],
        "A_dft_seq_im": _A_in["dft_seq_im"],
        "A_dft_hid_re": _A_in["dft_hid_re"],
        "A_dft_hid_im": _A_in["dft_hid_im"],
        "B_x": _B_in["x"],
        "B_wqkv": _B_in["wqkv"],
        "B_wo": _B_in["wo"],
        "gate_w": _w((lambda *s: torch.randn(*s, dtype=torch.bfloat16) * 0.05)(1024) * 16.0),
    }

def reference(A_x, A_dft_seq_re, A_dft_seq_im, A_dft_hid_re, A_dft_hid_im, B_x, B_wqkv, B_wo, gate_w):
    def _A_ref(x, dft_seq_re, dft_seq_im, dft_hid_re, dft_hid_im):
        a = torch.einsum("bsd,ed->bse", x, dft_hid_re)
        b = torch.einsum("bsd,ed->bse", x, dft_hid_im)
        y = torch.einsum("ts,bse->bte", dft_seq_re, a) - torch.einsum("ts,bse->bte", dft_seq_im, b)
        return y

    def _B_ref(x, wqkv, wo):
        B, S, D = x.shape
        H = 32; Dh = D // H
        qkv = (lambda x, *d: x.permute(*d))((x @ wqkv).reshape(B, S, 3, H, Dh), 2, 0, 3, 1, 4)
        q, k, v = qkv[0], qkv[1], qkv[2]
        scale = Dh ** -0.5
        scores = torch.einsum("bhqd,bhkd->bhqk", q, k) * scale
        p = _softmax(scores, axis=-1)
        o = torch.einsum("bhqk,bhkd->bhqd", p, v)
        return (lambda x, *d: x.permute(*d))(o, 0, 2, 1, 3).reshape(B, S, D) @ wo

    x = A_x
    g = _sigmoid((x * gate_w).sum(-1, keepdims=True))
    a = _A_ref(x, A_dft_seq_re, A_dft_seq_im, A_dft_hid_re, A_dft_hid_im)
    b = _B_ref(x, B_wqkv, B_wo)
    return g * a + (1 - g) * b
```

```asm
; @launch kernel=proj_kernel grid=(256,1,1) block=(256,1,1) lds=159744
; @launch kernel=mix_kernel grid=(256,1,1) block=(512,1,1) lds=163840
; @launch kernel=out_kernel grid=(256,1,1) block=(256,1,1) lds=147456
.amdgcn_target "amdgcn-amd-amdhsa--gfx950"
.text
.globl proj_kernel
.p2align 8
.type proj_kernel,@function
proj_kernel:
    s_cmp_ge_u32 s2, 256
    s_cbranch_scc1 proj_kernel_done
    s_load_dwordx2 s[4:5], s[0:1], 0
    s_load_dwordx4 s[32:35], s[0:1], 24
    s_load_dwordx2 s[36:37], s[0:1], 48
    s_load_dwordx2 s[40:41], s[0:1], 88
    v_lshrrev_b32 v1, 6, v0
    v_and_b32 v0, 63, v0
    v_readfirstlane_b32 s3, v1
    s_and_b32 s42, s2, 7
    s_lshr_b32 s43, s2, 3
    s_and_b32 s44, s42, 1
    s_lshl_b32 s44, s44, 2
    s_and_b32 s45, s43, 3
    s_add_u32 s44, s44, s45
    s_lshr_b32 s42, s42, 1
    s_lshl_b32 s42, s42, 3
    s_lshr_b32 s43, s43, 2
    s_add_u32 s43, s43, s42
    s_mov_b32 s42, s44
    s_lshl_b32 s44, s42, 8
    s_lshl_b32 s45, s3, 6
    s_add_u32 s44, s44, s45
    s_lshl_b32 s50, s3, 13
    s_lshl_b32 s51, s3, 10
    v_lshrrev_b32 v30, 3, v0
    v_and_b32 v31, 7, v0
    v_lshrrev_b32 v92, 4, v0
    v_lshlrev_b32 v29, 4, v0
    v_add_u32 v93, s44, v30
    v_lshlrev_b32 v93, 11, v93
    v_xor_b32 v1, v31, v92
    v_lshlrev_b32 v1, 4, v1
    v_add_u32 v1, v1, v93
    v_xor_b32 v2, 64, v1
    v_add_u32 v2, 16384, v2
    v_add_u32 v3, 32768, v1
    v_xor_b32 v4, 64, v1
    v_add_u32 v4, 49152, v4
    v_add_u32 v5, 65536, v1
    v_xor_b32 v6, 64, v1
    v_add_u32 v6, 81920, v6
    v_add_u32 v7, 98304, v1
    v_xor_b32 v8, 64, v1
    v_add_u32 v8, 114688, v8
    s_lshl_b32 s45, s43, 5
    s_lshl_b32 s46, s3, 3
    s_add_u32 s45, s45, s46
    v_add_u32 v93, s45, v30
    v_lshlrev_b32 v93, 11, v93
    s_lshl_b32 s46, s3, 2
    v_add_u32 v9, s46, v92
    v_and_b32 v9, 7, v9
    v_xor_b32 v9, v9, v31
    v_lshlrev_b32 v9, 4, v9
    v_add_u32 v9, v9, v93
    v_lshrrev_b32 v93, 2, v0
    s_lshl_b32 s46, s3, 4
    v_add_u32 v93, s46, v93
    s_movk_i32 s46, 6144
    v_mul_lo_u32 v93, v93, s46
    v_and_b32 v10, 3, v0
    v_lshlrev_b32 v10, 4, v10
    v_add_u32 v10, v10, v93
    s_lshl_b32 s46, s43, 6
    v_add_u32 v10, s46, v10
    v_add_u32 v88, 2048, v10
    v_add_u32 v89, 4096, v10
    s_waitcnt lgkmcnt(0)
    s_mov_b32 s8, s4
    s_mov_b32 s9, s5
    s_mov_b32 s10, 4194304
    s_mov_b32 s11, 0x00020000
    s_mov_b32 s12, s32
    s_mov_b32 s13, s33
    s_mov_b32 s14, 2097152
    s_mov_b32 s15, 0x00020000
    s_mov_b32 s16, s34
    s_mov_b32 s17, s35
    s_mov_b32 s18, 2097152
    s_mov_b32 s19, 0x00020000
    s_mov_b32 s20, s36
    s_mov_b32 s21, s37
    s_mov_b32 s22, 6291456
    s_mov_b32 s23, 0x00020000
    s_mov_b32 s47, 0
    s_mov_b32 s45, 0
    s_mov_b32 s46, 0
    s_mov_b32 s53, s50
    s_mov_b32 s54, s51
    s_add_u32 m0, s53, 0
    s_nop 0
    buffer_load_dwordx4 v1, s[8:11], s45 offen lds
    s_add_u32 m0, s53, 1024
    s_nop 0
    buffer_load_dwordx4 v2, s[8:11], s45 offen lds
    s_add_u32 m0, s53, 2048
    s_nop 0
    buffer_load_dwordx4 v3, s[8:11], s45 offen lds
    s_add_u32 m0, s53, 3072
    s_nop 0
    buffer_load_dwordx4 v4, s[8:11], s45 offen lds
    s_add_u32 m0, s53, 4096
    s_nop 0
    buffer_load_dwordx4 v5, s[8:11], s45 offen lds
    s_add_u32 m0, s53, 5120
    s_nop 0
    buffer_load_dwordx4 v6, s[8:11], s45 offen lds
    s_add_u32 m0, s53, 6144
    s_nop 0
    buffer_load_dwordx4 v7, s[8:11], s45 offen lds
    s_add_u32 m0, s53, 7168
    s_nop 0
    buffer_load_dwordx4 v8, s[8:11], s45 offen lds
    s_add_u32 m0, s54, 32768
    s_nop 0
    buffer_load_dwordx4 v9, s[12:15], s45 offen lds
    s_add_u32 m0, s54, 36864
    s_nop 0
    buffer_load_dwordx4 v9, s[16:19], s45 offen lds
    s_add_u32 m0, s54, 40960
    s_nop 0
    buffer_load_dwordx4 v10, s[20:23], s46 offen lds
    s_add_u32 m0, s54, 45056
    s_nop 0
    buffer_load_dwordx4 v88, s[20:23], s46 offen lds
    s_add_u32 m0, s54, 49152
    s_nop 0
    buffer_load_dwordx4 v89, s[20:23], s46 offen lds
    s_add_u32 s47, s47, 53248
    s_cmp_ge_u32 s47, 159744
    s_cselect_b32 s47, 0, s47
    s_add_u32 s53, s47, s50
    s_add_u32 s54, s47, s51
    s_add_u32 s45, s45, 128
    s_and_b32 s45, s45, 0x7ff
    s_mul_i32 s46, s45, 3072
    s_add_u32 m0, s53, 0
    s_mov_b32 s24, s40
    buffer_load_dwordx4 v1, s[8:11], s45 offen lds
    s_mov_b32 s25, s41
    s_mov_b32 s26, 41943040
    s_mov_b32 s27, 0x00020000
    v_lshrrev_b32 v30, 5, v0
    v_lshrrev_b32 v31, 1, v0
    v_and_b32 v31, 7, v31
    v_xor_b32 v30, v30, v31
    v_and_b32 v31, 31, v0
    v_lshlrev_b32 v31, 7, v31
    v_xor_b32 v92, 0, v30
    v_lshlrev_b32 v92, 4, v92
    v_add_u32 v92, v92, v31
    v_add_u32 v11, s50, v92
    v_add_u32 v15, 32768, v92
    v_xor_b32 v92, 2, v30
    v_lshlrev_b32 v92, 4, v92
    s_add_u32 m0, s53, 1024
    v_add_u32 v92, v92, v31
    buffer_load_dwordx4 v2, s[8:11], s45 offen lds
    v_add_u32 v12, s50, v92
    v_add_u32 v16, 32768, v92
    v_xor_b32 v92, 4, v30
    v_lshlrev_b32 v92, 4, v92
    v_add_u32 v92, v92, v31
    v_add_u32 v13, s50, v92
    v_add_u32 v17, 32768, v92
    v_xor_b32 v92, 6, v30
    v_lshlrev_b32 v92, 4, v92
    v_add_u32 v92, v92, v31
    v_add_u32 v14, s50, v92
    v_add_u32 v18, 32768, v92
    v_lshrrev_b32 v30, 5, v0
    v_lshlrev_b32 v30, 3, v30
    v_bfe_u32 v31, v0, 2, 2
    v_add_u32 v30, v30, v31
    s_add_u32 m0, s53, 2048
    v_lshlrev_b32 v30, 6, v30
    buffer_load_dwordx4 v3, s[8:11], s45 offen lds
    v_bfe_u32 v31, v0, 4, 1
    v_lshlrev_b32 v31, 5, v31
    v_add_u32 v30, v30, v31
    v_and_b32 v31, 3, v0
    v_lshlrev_b32 v31, 3, v31
    v_add_u32 v30, v30, v31
    v_add_u32 v19, 40960, v30
    v_mov_b32 v20, v11
    v_mov_b32 v24, v15
    v_mov_b32 v21, v12
    v_mov_b32 v25, v16
    v_mov_b32 v22, v13
    v_mov_b32 v26, v17
    v_mov_b32 v23, v14
    v_mov_b32 v27, v18
    v_mov_b32 v28, v19
    s_add_u32 m0, s53, 3072
    s_mov_b32 s48, 0
    buffer_load_dwordx4 v4, s[8:11], s45 offen lds
    s_mov_b32 s49, 0
    v_mov_b32 v96, 0
    v_mov_b32 v97, 0
    v_mov_b32 v98, 0
    v_mov_b32 v99, 0
    v_mov_b32 v100, 0
    v_mov_b32 v101, 0
    v_mov_b32 v102, 0
    v_mov_b32 v103, 0
    v_mov_b32 v104, 0
    v_mov_b32 v105, 0
    v_mov_b32 v106, 0
    v_mov_b32 v107, 0
    v_mov_b32 v108, 0
    v_mov_b32 v109, 0
    v_mov_b32 v110, 0
    s_add_u32 m0, s53, 4096
    v_mov_b32 v111, 0
    buffer_load_dwordx4 v5, s[8:11], s45 offen lds
    v_mov_b32 v112, 0
    v_mov_b32 v113, 0
    v_mov_b32 v114, 0
    v_mov_b32 v115, 0
    v_mov_b32 v116, 0
    v_mov_b32 v117, 0
    v_mov_b32 v118, 0
    v_mov_b32 v119, 0
    v_mov_b32 v120, 0
    v_mov_b32 v121, 0
    v_mov_b32 v122, 0
    v_mov_b32 v123, 0
    v_mov_b32 v124, 0
    v_mov_b32 v125, 0
    v_mov_b32 v126, 0
    v_mov_b32 v127, 0
    s_add_u32 m0, s53, 5120
    v_mov_b32 v128, 0
    buffer_load_dwordx4 v6, s[8:11], s45 offen lds
    v_mov_b32 v129, 0
    v_mov_b32 v130, 0
    v_mov_b32 v131, 0
    v_mov_b32 v132, 0
    v_mov_b32 v133, 0
    v_mov_b32 v134, 0
    v_mov_b32 v135, 0
    v_mov_b32 v136, 0
    v_mov_b32 v137, 0
    v_mov_b32 v138, 0
    v_mov_b32 v139, 0
    v_mov_b32 v140, 0
    v_mov_b32 v141, 0
    v_mov_b32 v142, 0
    v_mov_b32 v143, 0
    v_mov_b32 v144, 0
    s_add_u32 m0, s53, 6144
    v_mov_b32 v145, 0
    buffer_load_dwordx4 v7, s[8:11], s45 offen lds
    v_mov_b32 v146, 0
    v_mov_b32 v147, 0
    v_mov_b32 v148, 0
    v_mov_b32 v149, 0
    v_mov_b32 v150, 0
    v_mov_b32 v151, 0
    v_mov_b32 v152, 0
    v_mov_b32 v153, 0
    v_mov_b32 v154, 0
    v_mov_b32 v155, 0
    v_mov_b32 v156, 0
    v_mov_b32 v157, 0
    v_mov_b32 v158, 0
    v_mov_b32 v159, 0
    v_mov_b32 v160, 0
    v_mov_b32 v161, 0
    s_add_u32 m0, s53, 7168
    v_mov_b32 v162, 0
    buffer_load_dwordx4 v8, s[8:11], s45 offen lds
    v_mov_b32 v163, 0
    v_mov_b32 v164, 0
    v_mov_b32 v165, 0
    v_mov_b32 v166, 0
    v_mov_b32 v167, 0
    v_mov_b32 v168, 0
    v_mov_b32 v169, 0
    v_mov_b32 v170, 0
    v_mov_b32 v171, 0
    v_mov_b32 v172, 0
    v_mov_b32 v173, 0
    v_mov_b32 v174, 0
    v_mov_b32 v175, 0
    v_mov_b32 v176, 0
    v_mov_b32 v177, 0
    v_mov_b32 v178, 0
    s_add_u32 m0, s54, 32768
    v_mov_b32 v179, 0
    buffer_load_dwordx4 v9, s[12:15], s45 offen lds
    v_mov_b32 v180, 0
    v_mov_b32 v181, 0
    v_mov_b32 v182, 0
    v_mov_b32 v183, 0
    v_mov_b32 v184, 0
    v_mov_b32 v185, 0
    v_mov_b32 v186, 0
    v_mov_b32 v187, 0
    v_mov_b32 v188, 0
    v_mov_b32 v189, 0
    v_mov_b32 v190, 0
    v_mov_b32 v191, 0
    v_mov_b32 v192, 0
    v_mov_b32 v193, 0
    v_mov_b32 v194, 0
    v_mov_b32 v195, 0
    s_add_u32 m0, s54, 36864
    v_mov_b32 v196, 0
    buffer_load_dwordx4 v9, s[16:19], s45 offen lds
    v_mov_b32 v197, 0
    v_mov_b32 v198, 0
    v_mov_b32 v199, 0
    v_mov_b32 v200, 0
    v_mov_b32 v201, 0
    v_mov_b32 v202, 0
    v_mov_b32 v203, 0
    v_mov_b32 v204, 0
    v_mov_b32 v205, 0
    v_mov_b32 v206, 0
    v_mov_b32 v207, 0
    v_mov_b32 v208, 0
    v_mov_b32 v209, 0
    v_mov_b32 v210, 0
    v_mov_b32 v211, 0
    v_mov_b32 v212, 0
    s_add_u32 m0, s54, 40960
    v_mov_b32 v213, 0
    buffer_load_dwordx4 v10, s[20:23], s46 offen lds
    v_mov_b32 v214, 0
    v_mov_b32 v215, 0
    v_mov_b32 v216, 0
    v_mov_b32 v217, 0
    v_mov_b32 v218, 0
    v_mov_b32 v219, 0
    v_mov_b32 v220, 0
    v_mov_b32 v221, 0
    v_mov_b32 v222, 0
    v_mov_b32 v223, 0
    v_mov_b32 v224, 0
    v_mov_b32 v225, 0
    v_mov_b32 v226, 0
    v_mov_b32 v227, 0
    v_mov_b32 v228, 0
    v_mov_b32 v229, 0
    s_add_u32 m0, s54, 45056
    v_mov_b32 v230, 0
    buffer_load_dwordx4 v88, s[20:23], s46 offen lds
    v_mov_b32 v231, 0
    v_mov_b32 v232, 0
    v_mov_b32 v233, 0
    v_mov_b32 v234, 0
    v_mov_b32 v235, 0
    v_mov_b32 v236, 0
    v_mov_b32 v237, 0
    v_mov_b32 v238, 0
    v_mov_b32 v239, 0
    v_mov_b32 v240, 0
    v_mov_b32 v241, 0
    v_mov_b32 v242, 0
    v_mov_b32 v243, 0
    v_mov_b32 v244, 0
    v_mov_b32 v245, 0
    v_mov_b32 v246, 0
    s_add_u32 m0, s54, 49152
    v_mov_b32 v247, 0
    buffer_load_dwordx4 v89, s[20:23], s46 offen lds
    v_mov_b32 v248, 0
    v_mov_b32 v249, 0
    v_mov_b32 v250, 0
    v_mov_b32 v251, 0
    v_mov_b32 v252, 0
    v_mov_b32 v253, 0
    v_mov_b32 v254, 0
    v_mov_b32 v255, 0
    s_add_u32 s47, s47, 53248
    s_cmp_ge_u32 s47, 159744
    s_cselect_b32 s47, 0, s47
    s_add_u32 s53, s47, s50
    s_add_u32 s54, s47, s51
    s_add_u32 s45, s45, 128
    s_and_b32 s45, s45, 0x7ff
    s_mul_i32 s46, s45, 3072
    s_waitcnt vmcnt(13)
    s_barrier
    ds_read_b128 v[32:35], v20
    ds_read_b128 v[40:43], v24
    ds_read_b128 v[44:47], v24 offset:4096
    ds_read_b64_tr_b16 v[48:49], v28 offset:0
    ds_read_b64_tr_b16 v[50:51], v28 offset:256
    ds_read_b64_tr_b16 v[52:53], v28 offset:4096
    ds_read_b64_tr_b16 v[54:55], v28 offset:4352
    ds_read_b64_tr_b16 v[56:57], v28 offset:8192
    ds_read_b64_tr_b16 v[58:59], v28 offset:8448
    ds_read_b128 v[36:39], v20 offset:4096
proj_kernel_loop:
    s_waitcnt lgkmcnt(0)
    v_mfma_f32_32x32x16_bf16 v[96:111], v[32:35], v[40:43], v[96:111]
    s_add_u32 m0, s53, 0
    ds_read_b128 v[60:63], v21
    buffer_load_dwordx4 v1, s[8:11], s45 offen lds
    v_mfma_f32_32x32x16_bf16 v[112:127], v[32:35], v[44:47], v[112:127]
    s_add_u32 m0, s53, 1024
    ds_read_b128 v[68:71], v25
    v_mfma_f32_32x32x16_bf16 v[128:143], v[48:51], v[32:35], v[128:143]
    buffer_load_dwordx4 v2, s[8:11], s45 offen lds
    s_add_u32 m0, s53, 2048
    ds_read_b128 v[72:75], v25 offset:4096
    v_mfma_f32_32x32x16_bf16 v[144:159], v[52:55], v[32:35], v[144:159]
    buffer_load_dwordx4 v3, s[8:11], s45 offen lds
    s_add_u32 m0, s53, 3072
    v_mfma_f32_32x32x16_bf16 v[160:175], v[32:35], v[56:59], v[160:175]
    ds_read_b64_tr_b16 v[76:77], v28 offset:1024
    buffer_load_dwordx4 v4, s[8:11], s45 offen lds
    v_mfma_f32_32x32x16_bf16 v[176:191], v[36:39], v[40:43], v[176:191]
    s_add_u32 m0, s53, 4096
    ds_read_b64_tr_b16 v[78:79], v28 offset:1280
    buffer_load_dwordx4 v5, s[8:11], s45 offen lds
    v_mfma_f32_32x32x16_bf16 v[192:207], v[36:39], v[44:47], v[192:207]
    s_add_u32 m0, s53, 5120
    ds_read_b64_tr_b16 v[80:81], v28 offset:5120
    v_mfma_f32_32x32x16_bf16 v[208:223], v[48:51], v[36:39], v[208:223]
    buffer_load_dwordx4 v6, s[8:11], s45 offen lds
    s_add_u32 m0, s53, 6144
    ds_read_b64_tr_b16 v[82:83], v28 offset:5376
    v_mfma_f32_32x32x16_bf16 v[224:239], v[52:55], v[36:39], v[224:239]
    buffer_load_dwordx4 v7, s[8:11], s45 offen lds
    ds_read_b64_tr_b16 v[84:85], v28 offset:9216
    v_mfma_f32_32x32x16_bf16 v[240:255], v[36:39], v[56:59], v[240:255]
    ds_read_b64_tr_b16 v[86:87], v28 offset:9472
    ds_read_b128 v[64:67], v21 offset:4096
    s_waitcnt lgkmcnt(0)
    v_mfma_f32_32x32x16_bf16 v[96:111], v[60:63], v[68:71], v[96:111]
    s_add_u32 m0, s53, 7168
    ds_read_b128 v[32:35], v22
    buffer_load_dwordx4 v8, s[8:11], s45 offen lds
    v_mfma_f32_32x32x16_bf16 v[112:127], v[60:63], v[72:75], v[112:127]
    s_add_u32 m0, s54, 32768
    ds_read_b128 v[40:43], v26
    buffer_load_dwordx4 v9, s[12:15], s45 offen lds
    v_mfma_f32_32x32x16_bf16 v[128:143], v[76:79], v[60:63], v[128:143]
    s_add_u32 m0, s54, 36864
    ds_read_b128 v[44:47], v26 offset:4096
    buffer_load_dwordx4 v9, s[16:19], s45 offen lds
    v_mfma_f32_32x32x16_bf16 v[144:159], v[80:83], v[60:63], v[144:159]
    s_add_u32 m0, s54, 40960
    ds_read_b64_tr_b16 v[48:49], v28 offset:2048
    buffer_load_dwordx4 v10, s[20:23], s46 offen lds
    v_mfma_f32_32x32x16_bf16 v[160:175], v[60:63], v[84:87], v[160:175]
    s_add_u32 m0, s54, 45056
    ds_read_b64_tr_b16 v[50:51], v28 offset:2304
    buffer_load_dwordx4 v88, s[20:23], s46 offen lds
    v_mfma_f32_32x32x16_bf16 v[176:191], v[64:67], v[68:71], v[176:191]
    s_add_u32 m0, s54, 49152
    ds_read_b64_tr_b16 v[52:53], v28 offset:6144
    buffer_load_dwordx4 v89, s[20:23], s46 offen lds
    v_mfma_f32_32x32x16_bf16 v[192:207], v[64:67], v[72:75], v[192:207]
    ds_read_b64_tr_b16 v[54:55], v28 offset:6400
    ds_read_b64_tr_b16 v[56:57], v28 offset:10240
    ds_read_b64_tr_b16 v[58:59], v28 offset:10496
    v_mfma_f32_32x32x16_bf16 v[208:223], v[76:79], v[64:67], v[208:223]
    ds_read_b128 v[36:39], v22 offset:4096
    s_add_u32 s47, s47, 53248
    s_cmp_ge_u32 s47, 159744
    v_mfma_f32_32x32x16_bf16 v[224:239], v[80:83], v[64:67], v[224:239]
    s_cselect_b32 s47, 0, s47
    s_add_u32 s53, s47, s50
    s_add_u32 s54, s47, s51
    v_mfma_f32_32x32x16_bf16 v[240:255], v[64:67], v[84:87], v[240:255]
    s_add_u32 s45, s45, 128
    s_and_b32 s45, s45, 0x7ff
    s_mul_i32 s46, s45, 3072
    s_waitcnt lgkmcnt(0)
    v_mfma_f32_32x32x16_bf16 v[96:111], v[32:35], v[40:43], v[96:111]
    ds_read_b128 v[60:63], v23
    ds_read_b128 v[68:71], v27
    ds_read_b128 v[72:75], v27 offset:4096
    v_mfma_f32_32x32x16_bf16 v[112:127], v[32:35], v[44:47], v[112:127]
    ds_read_b64_tr_b16 v[76:77], v28 offset:3072
    ds_read_b64_tr_b16 v[78:79], v28 offset:3328
    v_mfma_f32_32x32x16_bf16 v[128:143], v[48:51], v[32:35], v[128:143]
    ds_read_b64_tr_b16 v[80:81], v28 offset:7168
    ds_read_b64_tr_b16 v[82:83], v28 offset:7424
    v_mfma_f32_32x32x16_bf16 v[144:159], v[52:55], v[32:35], v[144:159]
    ds_read_b64_tr_b16 v[84:85], v28 offset:11264
    ds_read_b64_tr_b16 v[86:87], v28 offset:11520
    v_mfma_f32_32x32x16_bf16 v[160:175], v[32:35], v[56:59], v[160:175]
    ds_read_b128 v[64:67], v23 offset:4096
    s_add_u32 s48, s48, 53248
    v_mfma_f32_32x32x16_bf16 v[176:191], v[36:39], v[40:43], v[176:191]
    s_cmp_ge_u32 s48, 159744
    s_cselect_b32 s48, 0, s48
    v_add_u32 v20, s48, v11
    v_mfma_f32_32x32x16_bf16 v[192:207], v[36:39], v[44:47], v[192:207]
    v_add_u32 v24, s48, v15
    v_add_u32 v21, s48, v12
    v_mfma_f32_32x32x16_bf16 v[208:223], v[48:51], v[36:39], v[208:223]
    v_add_u32 v25, s48, v16
    v_add_u32 v22, s48, v13
    v_mfma_f32_32x32x16_bf16 v[224:239], v[52:55], v[36:39], v[224:239]
    v_add_u32 v26, s48, v17
    v_add_u32 v23, s48, v14
    v_mfma_f32_32x32x16_bf16 v[240:255], v[36:39], v[56:59], v[240:255]
    v_add_u32 v27, s48, v18
    v_add_u32 v28, s48, v19
    s_waitcnt lgkmcnt(0)
    v_mfma_f32_32x32x16_bf16 v[96:111], v[60:63], v[68:71], v[96:111]
    v_mfma_f32_32x32x16_bf16 v[112:127], v[60:63], v[72:75], v[112:127]
    s_waitcnt vmcnt(13)
    s_barrier
    v_mfma_f32_32x32x16_bf16 v[128:143], v[76:79], v[60:63], v[128:143]
    ds_read_b128 v[32:35], v20
    ds_read_b128 v[40:43], v24
    v_mfma_f32_32x32x16_bf16 v[144:159], v[80:83], v[60:63], v[144:159]
    ds_read_b128 v[44:47], v24 offset:4096
    v_mfma_f32_32x32x16_bf16 v[160:175], v[60:63], v[84:87], v[160:175]
    ds_read_b64_tr_b16 v[48:49], v28 offset:0
    v_mfma_f32_32x32x16_bf16 v[176:191], v[64:67], v[68:71], v[176:191]
    ds_read_b64_tr_b16 v[50:51], v28 offset:256
    v_mfma_f32_32x32x16_bf16 v[192:207], v[64:67], v[72:75], v[192:207]
    ds_read_b64_tr_b16 v[52:53], v28 offset:4096
    ds_read_b64_tr_b16 v[54:55], v28 offset:4352
    v_mfma_f32_32x32x16_bf16 v[208:223], v[76:79], v[64:67], v[208:223]
    ds_read_b64_tr_b16 v[56:57], v28 offset:8192
    v_mfma_f32_32x32x16_bf16 v[224:239], v[80:83], v[64:67], v[224:239]
    ds_read_b64_tr_b16 v[58:59], v28 offset:8448
    v_mfma_f32_32x32x16_bf16 v[240:255], v[64:67], v[84:87], v[240:255]
    ds_read_b128 v[36:39], v20 offset:4096
    s_add_u32 s49, s49, 1
    s_cmp_lt_u32 s49, 14
    s_cbranch_scc1 proj_kernel_loop
    s_waitcnt lgkmcnt(0)
    v_mfma_f32_32x32x16_bf16 v[96:111], v[32:35], v[40:43], v[96:111]
    ds_read_b128 v[60:63], v21
    v_mfma_f32_32x32x16_bf16 v[112:127], v[32:35], v[44:47], v[112:127]
    ds_read_b128 v[68:71], v25
    v_mfma_f32_32x32x16_bf16 v[128:143], v[48:51], v[32:35], v[128:143]
    ds_read_b128 v[72:75], v25 offset:4096
    v_mfma_f32_32x32x16_bf16 v[144:159], v[52:55], v[32:35], v[144:159]
    ds_read_b64_tr_b16 v[76:77], v28 offset:1024
    v_mfma_f32_32x32x16_bf16 v[160:175], v[32:35], v[56:59], v[160:175]
    ds_read_b64_tr_b16 v[78:79], v28 offset:1280
    v_mfma_f32_32x32x16_bf16 v[176:191], v[36:39], v[40:43], v[176:191]
    ds_read_b64_tr_b16 v[80:81], v28 offset:5120
    v_mfma_f32_32x32x16_bf16 v[192:207], v[36:39], v[44:47], v[192:207]
    ds_read_b64_tr_b16 v[82:83], v28 offset:5376
    v_mfma_f32_32x32x16_bf16 v[208:223], v[48:51], v[36:39], v[208:223]
    ds_read_b64_tr_b16 v[84:85], v28 offset:9216
    v_mfma_f32_32x32x16_bf16 v[224:239], v[52:55], v[36:39], v[224:239]
    ds_read_b64_tr_b16 v[86:87], v28 offset:9472
    v_mfma_f32_32x32x16_bf16 v[240:255], v[36:39], v[56:59], v[240:255]
    ds_read_b128 v[64:67], v21 offset:4096
    s_waitcnt lgkmcnt(0)
    v_mfma_f32_32x32x16_bf16 v[96:111], v[60:63], v[68:71], v[96:111]
    ds_read_b128 v[32:35], v22
    v_mfma_f32_32x32x16_bf16 v[112:127], v[60:63], v[72:75], v[112:127]
    ds_read_b128 v[40:43], v26
    v_mfma_f32_32x32x16_bf16 v[128:143], v[76:79], v[60:63], v[128:143]
    ds_read_b128 v[44:47], v26 offset:4096
    v_mfma_f32_32x32x16_bf16 v[144:159], v[80:83], v[60:63], v[144:159]
    ds_read_b64_tr_b16 v[48:49], v28 offset:2048
    v_mfma_f32_32x32x16_bf16 v[160:175], v[60:63], v[84:87], v[160:175]
    ds_read_b64_tr_b16 v[50:51], v28 offset:2304
    v_mfma_f32_32x32x16_bf16 v[176:191], v[64:67], v[68:71], v[176:191]
    ds_read_b64_tr_b16 v[52:53], v28 offset:6144
    v_mfma_f32_32x32x16_bf16 v[192:207], v[64:67], v[72:75], v[192:207]
    ds_read_b64_tr_b16 v[54:55], v28 offset:6400
    v_mfma_f32_32x32x16_bf16 v[208:223], v[76:79], v[64:67], v[208:223]
    ds_read_b64_tr_b16 v[56:57], v28 offset:10240
    v_mfma_f32_32x32x16_bf16 v[224:239], v[80:83], v[64:67], v[224:239]
    ds_read_b64_tr_b16 v[58:59], v28 offset:10496
    v_mfma_f32_32x32x16_bf16 v[240:255], v[64:67], v[84:87], v[240:255]
    ds_read_b128 v[36:39], v22 offset:4096
    s_waitcnt lgkmcnt(0)
    v_mfma_f32_32x32x16_bf16 v[96:111], v[32:35], v[40:43], v[96:111]
    ds_read_b128 v[60:63], v23
    ds_read_b128 v[68:71], v27
    ds_read_b128 v[72:75], v27 offset:4096
    v_mfma_f32_32x32x16_bf16 v[112:127], v[32:35], v[44:47], v[112:127]
    ds_read_b64_tr_b16 v[76:77], v28 offset:3072
    ds_read_b64_tr_b16 v[78:79], v28 offset:3328
    v_mfma_f32_32x32x16_bf16 v[128:143], v[48:51], v[32:35], v[128:143]
    ds_read_b64_tr_b16 v[80:81], v28 offset:7168
    ds_read_b64_tr_b16 v[82:83], v28 offset:7424
    v_mfma_f32_32x32x16_bf16 v[144:159], v[52:55], v[32:35], v[144:159]
    ds_read_b64_tr_b16 v[84:85], v28 offset:11264
    ds_read_b64_tr_b16 v[86:87], v28 offset:11520
    v_mfma_f32_32x32x16_bf16 v[160:175], v[32:35], v[56:59], v[160:175]
    ds_read_b128 v[64:67], v23 offset:4096
    s_add_u32 s48, s48, 53248
    v_mfma_f32_32x32x16_bf16 v[176:191], v[36:39], v[40:43], v[176:191]
    s_cmp_ge_u32 s48, 159744
    s_cselect_b32 s48, 0, s48
    v_add_u32 v20, s48, v11
    v_mfma_f32_32x32x16_bf16 v[192:207], v[36:39], v[44:47], v[192:207]
    v_add_u32 v24, s48, v15
    v_add_u32 v21, s48, v12
    v_mfma_f32_32x32x16_bf16 v[208:223], v[48:51], v[36:39], v[208:223]
    v_add_u32 v25, s48, v16
    v_add_u32 v22, s48, v13
    v_mfma_f32_32x32x16_bf16 v[224:239], v[52:55], v[36:39], v[224:239]
    v_add_u32 v26, s48, v17
    v_add_u32 v23, s48, v14
    v_mfma_f32_32x32x16_bf16 v[240:255], v[36:39], v[56:59], v[240:255]
    v_add_u32 v27, s48, v18
    v_add_u32 v28, s48, v19
    s_waitcnt lgkmcnt(0)
    v_mfma_f32_32x32x16_bf16 v[96:111], v[60:63], v[68:71], v[96:111]
    v_mfma_f32_32x32x16_bf16 v[112:127], v[60:63], v[72:75], v[112:127]
    s_waitcnt vmcnt(0)
    s_barrier
    v_mfma_f32_32x32x16_bf16 v[128:143], v[76:79], v[60:63], v[128:143]
    ds_read_b128 v[32:35], v20
    ds_read_b128 v[40:43], v24
    v_mfma_f32_32x32x16_bf16 v[144:159], v[80:83], v[60:63], v[144:159]
    ds_read_b128 v[44:47], v24 offset:4096
    v_mfma_f32_32x32x16_bf16 v[160:175], v[60:63], v[84:87], v[160:175]
    ds_read_b64_tr_b16 v[48:49], v28 offset:0
    v_mfma_f32_32x32x16_bf16 v[176:191], v[64:67], v[68:71], v[176:191]
    ds_read_b64_tr_b16 v[50:51], v28 offset:256
    v_mfma_f32_32x32x16_bf16 v[192:207], v[64:67], v[72:75], v[192:207]
    ds_read_b64_tr_b16 v[52:53], v28 offset:4096
    ds_read_b64_tr_b16 v[54:55], v28 offset:4352
    v_mfma_f32_32x32x16_bf16 v[208:223], v[76:79], v[64:67], v[208:223]
    ds_read_b64_tr_b16 v[56:57], v28 offset:8192
    v_mfma_f32_32x32x16_bf16 v[224:239], v[80:83], v[64:67], v[224:239]
    ds_read_b64_tr_b16 v[58:59], v28 offset:8448
    v_mfma_f32_32x32x16_bf16 v[240:255], v[64:67], v[84:87], v[240:255]
    ds_read_b128 v[36:39], v20 offset:4096
    s_waitcnt lgkmcnt(0)
    v_mfma_f32_32x32x16_bf16 v[96:111], v[32:35], v[40:43], v[96:111]
    ds_read_b128 v[60:63], v21
    v_mfma_f32_32x32x16_bf16 v[112:127], v[32:35], v[44:47], v[112:127]
    ds_read_b128 v[68:71], v25
    v_mfma_f32_32x32x16_bf16 v[128:143], v[48:51], v[32:35], v[128:143]
    ds_read_b128 v[72:75], v25 offset:4096
    v_mfma_f32_32x32x16_bf16 v[144:159], v[52:55], v[32:35], v[144:159]
    ds_read_b64_tr_b16 v[76:77], v28 offset:1024
    v_mfma_f32_32x32x16_bf16 v[160:175], v[32:35], v[56:59], v[160:175]
    ds_read_b64_tr_b16 v[78:79], v28 offset:1280
    v_mfma_f32_32x32x16_bf16 v[176:191], v[36:39], v[40:43], v[176:191]
    ds_read_b64_tr_b16 v[80:81], v28 offset:5120
    v_mfma_f32_32x32x16_bf16 v[192:207], v[36:39], v[44:47], v[192:207]
    ds_read_b64_tr_b16 v[82:83], v28 offset:5376
    v_mfma_f32_32x32x16_bf16 v[208:223], v[48:51], v[36:39], v[208:223]
    ds_read_b64_tr_b16 v[84:85], v28 offset:9216
    v_mfma_f32_32x32x16_bf16 v[224:239], v[52:55], v[36:39], v[224:239]
    ds_read_b64_tr_b16 v[86:87], v28 offset:9472
    v_mfma_f32_32x32x16_bf16 v[240:255], v[36:39], v[56:59], v[240:255]
    ds_read_b128 v[64:67], v21 offset:4096
    s_waitcnt lgkmcnt(0)
    v_mfma_f32_32x32x16_bf16 v[96:111], v[60:63], v[68:71], v[96:111]
    ds_read_b128 v[32:35], v22
    v_mfma_f32_32x32x16_bf16 v[112:127], v[60:63], v[72:75], v[112:127]
    ds_read_b128 v[40:43], v26
    v_mfma_f32_32x32x16_bf16 v[128:143], v[76:79], v[60:63], v[128:143]
    ds_read_b128 v[44:47], v26 offset:4096
    v_mfma_f32_32x32x16_bf16 v[144:159], v[80:83], v[60:63], v[144:159]
    ds_read_b64_tr_b16 v[48:49], v28 offset:2048
    v_mfma_f32_32x32x16_bf16 v[160:175], v[60:63], v[84:87], v[160:175]
    ds_read_b64_tr_b16 v[50:51], v28 offset:2304
    v_mfma_f32_32x32x16_bf16 v[176:191], v[64:67], v[68:71], v[176:191]
    ds_read_b64_tr_b16 v[52:53], v28 offset:6144
    v_mfma_f32_32x32x16_bf16 v[192:207], v[64:67], v[72:75], v[192:207]
    ds_read_b64_tr_b16 v[54:55], v28 offset:6400
    v_mfma_f32_32x32x16_bf16 v[208:223], v[76:79], v[64:67], v[208:223]
    ds_read_b64_tr_b16 v[56:57], v28 offset:10240
    v_mfma_f32_32x32x16_bf16 v[224:239], v[80:83], v[64:67], v[224:239]
    ds_read_b64_tr_b16 v[58:59], v28 offset:10496
    v_mfma_f32_32x32x16_bf16 v[240:255], v[64:67], v[84:87], v[240:255]
    ds_read_b128 v[36:39], v22 offset:4096
    s_waitcnt lgkmcnt(0)
    v_mfma_f32_32x32x16_bf16 v[96:111], v[32:35], v[40:43], v[96:111]
    ds_read_b128 v[60:63], v23
    v_mfma_f32_32x32x16_bf16 v[112:127], v[32:35], v[44:47], v[112:127]
    ds_read_b128 v[68:71], v27
    v_mfma_f32_32x32x16_bf16 v[128:143], v[48:51], v[32:35], v[128:143]
    ds_read_b128 v[72:75], v27 offset:4096
    v_mfma_f32_32x32x16_bf16 v[144:159], v[52:55], v[32:35], v[144:159]
    ds_read_b64_tr_b16 v[76:77], v28 offset:3072
    v_mfma_f32_32x32x16_bf16 v[160:175], v[32:35], v[56:59], v[160:175]
    ds_read_b64_tr_b16 v[78:79], v28 offset:3328
    v_mfma_f32_32x32x16_bf16 v[176:191], v[36:39], v[40:43], v[176:191]
    ds_read_b64_tr_b16 v[80:81], v28 offset:7168
    v_mfma_f32_32x32x16_bf16 v[192:207], v[36:39], v[44:47], v[192:207]
    ds_read_b64_tr_b16 v[82:83], v28 offset:7424
    v_mfma_f32_32x32x16_bf16 v[208:223], v[48:51], v[36:39], v[208:223]
    ds_read_b64_tr_b16 v[84:85], v28 offset:11264
    v_mfma_f32_32x32x16_bf16 v[224:239], v[52:55], v[36:39], v[224:239]
    ds_read_b64_tr_b16 v[86:87], v28 offset:11520
    v_mfma_f32_32x32x16_bf16 v[240:255], v[36:39], v[56:59], v[240:255]
    ds_read_b128 v[64:67], v23 offset:4096
    s_waitcnt lgkmcnt(0)
    v_mfma_f32_32x32x16_bf16 v[96:111], v[60:63], v[68:71], v[96:111]
    v_mfma_f32_32x32x16_bf16 v[112:127], v[60:63], v[72:75], v[112:127]
    v_mfma_f32_32x32x16_bf16 v[128:143], v[76:79], v[60:63], v[128:143]
    v_mfma_f32_32x32x16_bf16 v[144:159], v[80:83], v[60:63], v[144:159]
    v_mfma_f32_32x32x16_bf16 v[160:175], v[60:63], v[84:87], v[160:175]
    v_mfma_f32_32x32x16_bf16 v[176:191], v[64:67], v[68:71], v[176:191]
    v_mfma_f32_32x32x16_bf16 v[192:207], v[64:67], v[72:75], v[192:207]
    v_mfma_f32_32x32x16_bf16 v[208:223], v[76:79], v[64:67], v[208:223]
    v_mfma_f32_32x32x16_bf16 v[224:239], v[80:83], v[64:67], v[224:239]
    v_mfma_f32_32x32x16_bf16 v[240:255], v[64:67], v[84:87], v[240:255]
    s_nop 7
    s_lshl_b32 s45, s43, 17
    s_lshl_b32 s46, s42, 14
    s_add_u32 s45, s45, s46
    s_lshl_b32 s46, s3, 12
    s_add_u32 s45, s45, s46
    s_mov_b32 s57, 0x3e8293ee
    s_mov_b32 s46, s45
    v_cvt_pk_bf16_f32 v32, v96, v97
    v_cvt_pk_bf16_f32 v33, v98, v99
    v_cvt_pk_bf16_f32 v34, v100, v101
    v_cvt_pk_bf16_f32 v35, v102, v103
    v_cvt_pk_bf16_f32 v36, v104, v105
    v_cvt_pk_bf16_f32 v37, v106, v107
    v_cvt_pk_bf16_f32 v38, v108, v109
    v_cvt_pk_bf16_f32 v39, v110, v111
    s_nop 1
    v_permlane32_swap_b32 v32, v34
    v_permlane32_swap_b32 v33, v35
    v_permlane32_swap_b32 v36, v38
    v_permlane32_swap_b32 v37, v39
    buffer_store_dwordx4 v[32:35], v29, s[24:27], s45 offen offset:0 nt
    buffer_store_dwordx4 v[36:39], v29, s[24:27], s45 offen offset:1024 nt
    v_cvt_pk_bf16_f32 v40, v176, v177
    v_cvt_pk_bf16_f32 v41, v178, v179
    v_cvt_pk_bf16_f32 v42, v180, v181
    v_cvt_pk_bf16_f32 v43, v182, v183
    v_cvt_pk_bf16_f32 v44, v184, v185
    v_cvt_pk_bf16_f32 v45, v186, v187
    v_cvt_pk_bf16_f32 v46, v188, v189
    v_cvt_pk_bf16_f32 v47, v190, v191
    s_nop 1
    v_permlane32_swap_b32 v40, v42
    v_permlane32_swap_b32 v41, v43
    v_permlane32_swap_b32 v44, v46
    v_permlane32_swap_b32 v45, v47
    buffer_store_dwordx4 v[40:43], v29, s[24:27], s45 offen offset:2048 nt
    buffer_store_dwordx4 v[44:47], v29, s[24:27], s45 offen offset:3072 nt
    s_add_u32 s45, s45, 4194304
    v_cvt_pk_bf16_f32 v48, v112, v113
    v_cvt_pk_bf16_f32 v49, v114, v115
    v_cvt_pk_bf16_f32 v50, v116, v117
    v_cvt_pk_bf16_f32 v51, v118, v119
    v_cvt_pk_bf16_f32 v52, v120, v121
    v_cvt_pk_bf16_f32 v53, v122, v123
    v_cvt_pk_bf16_f32 v54, v124, v125
    v_cvt_pk_bf16_f32 v55, v126, v127
    s_nop 1
    v_permlane32_swap_b32 v48, v50
    v_permlane32_swap_b32 v49, v51
    v_permlane32_swap_b32 v52, v54
    v_permlane32_swap_b32 v53, v55
    buffer_store_dwordx4 v[48:51], v29, s[24:27], s45 offen offset:0 nt
    buffer_store_dwordx4 v[52:55], v29, s[24:27], s45 offen offset:1024 nt
    v_cvt_pk_bf16_f32 v56, v192, v193
    v_cvt_pk_bf16_f32 v57, v194, v195
    v_cvt_pk_bf16_f32 v58, v196, v197
    v_cvt_pk_bf16_f32 v59, v198, v199
    v_cvt_pk_bf16_f32 v60, v200, v201
    v_cvt_pk_bf16_f32 v61, v202, v203
    v_cvt_pk_bf16_f32 v62, v204, v205
    v_cvt_pk_bf16_f32 v63, v206, v207
    s_nop 1
    v_permlane32_swap_b32 v56, v58
    v_permlane32_swap_b32 v57, v59
    v_permlane32_swap_b32 v60, v62
    v_permlane32_swap_b32 v61, v63
    buffer_store_dwordx4 v[56:59], v29, s[24:27], s45 offen offset:2048 nt
    buffer_store_dwordx4 v[60:63], v29, s[24:27], s45 offen offset:3072 nt
    s_add_u32 s45, s45, 4194304
    v_mul_f32 v128, s57, v128
    v_mul_f32 v129, s57, v129
    v_mul_f32 v130, s57, v130
    v_mul_f32 v131, s57, v131
    v_mul_f32 v132, s57, v132
    v_mul_f32 v133, s57, v133
    v_mul_f32 v134, s57, v134
    v_mul_f32 v135, s57, v135
    v_mul_f32 v136, s57, v136
    v_mul_f32 v137, s57, v137
    v_mul_f32 v138, s57, v138
    v_mul_f32 v139, s57, v139
    v_mul_f32 v140, s57, v140
    v_mul_f32 v141, s57, v141
    v_mul_f32 v142, s57, v142
    v_mul_f32 v143, s57, v143
    v_cvt_pk_bf16_f32 v64, v128, v129
    v_cvt_pk_bf16_f32 v65, v130, v131
    v_cvt_pk_bf16_f32 v66, v132, v133
    v_cvt_pk_bf16_f32 v67, v134, v135
    v_cvt_pk_bf16_f32 v68, v136, v137
    v_cvt_pk_bf16_f32 v69, v138, v139
    v_cvt_pk_bf16_f32 v70, v140, v141
    v_cvt_pk_bf16_f32 v71, v142, v143
    buffer_store_dwordx4 v[64:67], v29, s[24:27], s45 offen offset:0 nt
    buffer_store_dwordx4 v[68:71], v29, s[24:27], s45 offen offset:1024 nt
    v_mul_f32 v208, s57, v208
    v_mul_f32 v209, s57, v209
    v_mul_f32 v210, s57, v210
    v_mul_f32 v211, s57, v211
    v_mul_f32 v212, s57, v212
    v_mul_f32 v213, s57, v213
    v_mul_f32 v214, s57, v214
    v_mul_f32 v215, s57, v215
    v_mul_f32 v216, s57, v216
    v_mul_f32 v217, s57, v217
    v_mul_f32 v218, s57, v218
    v_mul_f32 v219, s57, v219
    v_mul_f32 v220, s57, v220
    v_mul_f32 v221, s57, v221
    v_mul_f32 v222, s57, v222
    v_mul_f32 v223, s57, v223
    v_cvt_pk_bf16_f32 v72, v208, v209
    v_cvt_pk_bf16_f32 v73, v210, v211
    v_cvt_pk_bf16_f32 v74, v212, v213
    v_cvt_pk_bf16_f32 v75, v214, v215
    v_cvt_pk_bf16_f32 v76, v216, v217
    v_cvt_pk_bf16_f32 v77, v218, v219
    v_cvt_pk_bf16_f32 v78, v220, v221
    v_cvt_pk_bf16_f32 v79, v222, v223
    buffer_store_dwordx4 v[72:75], v29, s[24:27], s45 offen offset:2048 nt
    buffer_store_dwordx4 v[76:79], v29, s[24:27], s45 offen offset:3072 nt
    s_add_u32 s45, s45, 4194304
    v_cvt_pk_bf16_f32 v80, v144, v145
    v_cvt_pk_bf16_f32 v81, v146, v147
    v_cvt_pk_bf16_f32 v82, v148, v149
    v_cvt_pk_bf16_f32 v83, v150, v151
    v_cvt_pk_bf16_f32 v84, v152, v153
    v_cvt_pk_bf16_f32 v85, v154, v155
    v_cvt_pk_bf16_f32 v86, v156, v157
    v_cvt_pk_bf16_f32 v87, v158, v159
    buffer_store_dwordx4 v[80:83], v29, s[24:27], s45 offen offset:0 nt
    buffer_store_dwordx4 v[84:87], v29, s[24:27], s45 offen offset:1024 nt
    v_cvt_pk_bf16_f32 v32, v224, v225
    v_cvt_pk_bf16_f32 v33, v226, v227
    v_cvt_pk_bf16_f32 v34, v228, v229
    v_cvt_pk_bf16_f32 v35, v230, v231
    v_cvt_pk_bf16_f32 v36, v232, v233
    v_cvt_pk_bf16_f32 v37, v234, v235
    v_cvt_pk_bf16_f32 v38, v236, v237
    v_cvt_pk_bf16_f32 v39, v238, v239
    buffer_store_dwordx4 v[32:35], v29, s[24:27], s45 offen offset:2048 nt
    buffer_store_dwordx4 v[36:39], v29, s[24:27], s45 offen offset:3072 nt
    s_add_u32 s45, s45, 4194304
    v_cvt_pk_bf16_f32 v40, v160, v161
    v_cvt_pk_bf16_f32 v41, v162, v163
    v_cvt_pk_bf16_f32 v42, v168, v169
    v_cvt_pk_bf16_f32 v43, v170, v171
    v_cvt_pk_bf16_f32 v44, v164, v165
    v_cvt_pk_bf16_f32 v45, v166, v167
    v_cvt_pk_bf16_f32 v46, v172, v173
    v_cvt_pk_bf16_f32 v47, v174, v175
    buffer_store_dwordx4 v[40:43], v29, s[24:27], s45 offen offset:0 nt
    buffer_store_dwordx4 v[44:47], v29, s[24:27], s45 offen offset:1024 nt
    v_cvt_pk_bf16_f32 v48, v240, v241
    v_cvt_pk_bf16_f32 v49, v242, v243
    v_cvt_pk_bf16_f32 v50, v248, v249
    v_cvt_pk_bf16_f32 v51, v250, v251
    v_cvt_pk_bf16_f32 v52, v244, v245
    v_cvt_pk_bf16_f32 v53, v246, v247
    v_cvt_pk_bf16_f32 v54, v252, v253
    v_cvt_pk_bf16_f32 v55, v254, v255
    buffer_store_dwordx4 v[48:51], v29, s[24:27], s45 offen offset:2048 nt
    buffer_store_dwordx4 v[52:55], v29, s[24:27], s45 offen offset:3072 nt
    s_add_u32 s45, s45, 4194304
proj_kernel_done:
    s_endpgm
.globl mix_kernel
.p2align 8
.type mix_kernel,@function
mix_kernel:
    s_cmp_ge_u32 s2, 256
    s_cbranch_scc1 mix_kernel_a_done
    v_lshrrev_b32 v1, 6, v0
    v_and_b32 v0, 63, v0
    v_readfirstlane_b32 s3, v1
    s_nop 3
    s_cmp_ge_u32 s3, 4
    s_cbranch_scc1 mix_kernel_ystart
    s_load_dwordx2 s[40:41], s[0:1], 88
    s_load_dwordx2 s[4:5], s[0:1], 0
    s_load_dwordx2 s[38:39], s[0:1], 64
    s_and_b32 s42, s2, 7
    s_lshr_b32 s43, s2, 3
    s_lshl_b32 s42, s42, 2
    s_lshr_b32 s44, s43, 3
    s_add_u32 s42, s42, s44
    s_and_b32 s43, s43, 7
    s_lshl_b32 s43, s43, 3
    s_lshl_b32 s44, s3, 1
    s_add_u32 s43, s43, s44
    s_lshl_b32 s44, s42, 17
    v_lshlrev_b32 v1, 4, v0
    v_and_b32 v5, 15, v0
    v_bfe_u32 v6, v0, 4, 1
    v_lshlrev_b32 v6, 5, v6
    v_add_u32 v5, v5, v6
    v_lshlrev_b32 v5, 4, v5
    v_lshrrev_b32 v6, 5, v0
    v_lshlrev_b32 v7, 10, v6
    v_add_u32 v4, v5, v7
    v_lshlrev_b32 v7, 3, v6
    v_add_u32 v9, v5, v7
    s_waitcnt lgkmcnt(0)
    s_mov_b32 s24, s40
    s_mov_b32 s25, s41
    s_mov_b32 s26, 41943040
    s_mov_b32 s27, 0x00020000
    s_mov_b32 s8, s4
    s_mov_b32 s9, s5
    s_mov_b32 s10, 4194304
    s_mov_b32 s11, 0x00020000
    s_mov_b32 s28, s38
    s_mov_b32 s29, s39
    s_mov_b32 s30, 2048
    s_mov_b32 s31, 0x00020000
    s_lshl_b32 s45, s43, 11
    s_add_u32 s45, s45, s44
    s_add_u32 s45, s45, 8388608
    s_add_u32 s46, s44, 12582912
    s_add_u32 s47, s44, 16777216
    buffer_load_dwordx4 v[16:19], v4, s[24:27], s45 offen offset:0
    buffer_load_dwordx4 v[20:23], v4, s[24:27], s45 offen offset:256
    buffer_load_dwordx4 v[24:27], v4, s[24:27], s45 offen offset:2048
    buffer_load_dwordx4 v[28:31], v4, s[24:27], s45 offen offset:2304
    buffer_load_dwordx4 v[144:147], v4, s[24:27], s46 offen offset:0
    buffer_load_dwordx4 v[148:151], v4, s[24:27], s46 offen offset:256
    buffer_load_dwordx4 v[152:155], v4, s[24:27], s46 offen offset:2048
    buffer_load_dwordx4 v[156:159], v4, s[24:27], s46 offen offset:2304
    s_lshl_b32 s51, s3, 10
    s_mov_b32 s61, s51
    s_add_u32 s60, s61, 2048
    s_add_u32 s48, s46, s60
    s_add_u32 s49, s47, s61
    s_mov_b32 s50, s51
    s_mov_b32 m0, s50
    s_nop 0
    buffer_load_dwordx4 v1, s[24:27], s48 offen lds
    s_add_u32 m0, s50, 4096
    s_nop 0
    buffer_load_dwordx4 v1, s[24:27], s49 offen lds
    s_add_u32 s60, s60, 4096
    s_and_b32 s60, s60, 0x1ffff
    s_add_u32 s61, s61, 4096
    s_and_b32 s61, s61, 0x1ffff
    s_add_u32 s48, s46, s60
    s_add_u32 s49, s47, s61
    s_add_u32 s50, s50, 8192
    s_and_b32 s50, s50, 32767
    s_mov_b32 m0, s50
    s_nop 0
    buffer_load_dwordx4 v1, s[24:27], s48 offen lds
    s_add_u32 m0, s50, 4096
    s_nop 0
    buffer_load_dwordx4 v1, s[24:27], s49 offen lds
    s_add_u32 s60, s60, 4096
    s_and_b32 s60, s60, 0x1ffff
    s_add_u32 s61, s61, 4096
    s_and_b32 s61, s61, 0x1ffff
    s_add_u32 s48, s46, s60
    s_add_u32 s49, s47, s61
    s_add_u32 s50, s50, 8192
    s_and_b32 s50, s50, 32767
    s_mov_b32 m0, s50
    s_nop 0
    buffer_load_dwordx4 v1, s[24:27], s48 offen lds
    s_add_u32 m0, s50, 4096
    s_nop 0
    buffer_load_dwordx4 v1, s[24:27], s49 offen lds
    s_add_u32 s60, s60, 4096
    s_and_b32 s60, s60, 0x1ffff
    s_add_u32 s61, s61, 4096
    s_and_b32 s61, s61, 0x1ffff
    s_add_u32 s48, s46, s60
    s_add_u32 s49, s47, s61
    s_add_u32 s50, s50, 8192
    s_and_b32 s50, s50, 32767
    s_lshl_b32 s62, s2, 3
    s_lshl_b32 s45, s3, 1
    s_add_u32 s62, s62, s45
    s_lshl_b32 s45, s62, 11
    v_lshlrev_b32 v5, 5, v0
    buffer_load_dwordx4 v[192:195], v5, s[8:11], s45 offen
    buffer_load_dwordx4 v[196:199], v5, s[8:11], s45 offen offset:16
    buffer_load_dwordx4 v[200:203], v5, s[8:11], s45 offen offset:2048
    buffer_load_dwordx4 v[204:207], v5, s[8:11], s45 offen offset:2064
    buffer_load_dwordx4 v[208:211], v5, s[28:31], 0 offen
    buffer_load_dwordx4 v[212:215], v5, s[28:31], 0 offen offset:16
    v_mov_b32 v112, 0
    v_mov_b32 v113, 0
    v_mov_b32 v114, 0
    v_mov_b32 v115, 0
    v_mov_b32 v116, 0
    v_mov_b32 v117, 0
    v_mov_b32 v118, 0
    v_mov_b32 v119, 0
    v_mov_b32 v120, 0
    v_mov_b32 v121, 0
    v_mov_b32 v122, 0
    v_mov_b32 v123, 0
    v_mov_b32 v124, 0
    v_mov_b32 v125, 0
    v_mov_b32 v126, 0
    v_mov_b32 v127, 0
    v_mov_b32 v72, 0
    v_mov_b32 v73, 0
    v_mov_b32 v74, 0
    v_mov_b32 v75, 0
    v_mov_b32 v76, 0
    v_mov_b32 v77, 0
    v_mov_b32 v78, 0
    v_mov_b32 v79, 0
    v_mov_b32 v160, 0
    v_mov_b32 v161, 0
    v_mov_b32 v162, 0
    v_mov_b32 v163, 0
    v_mov_b32 v164, 0
    v_mov_b32 v165, 0
    v_mov_b32 v166, 0
    v_mov_b32 v167, 0
    v_mov_b32 v168, 0
    v_mov_b32 v169, 0
    v_mov_b32 v170, 0
    v_mov_b32 v171, 0
    v_mov_b32 v172, 0
    v_mov_b32 v173, 0
    v_mov_b32 v174, 0
    v_mov_b32 v175, 0
    v_mov_b32 v176, 0x3f803f80
    v_mov_b32 v177, 0x3f803f80
    v_mov_b32 v178, 0x3f803f80
    v_mov_b32 v179, 0x3f803f80
    v_mov_b32 v2, v4
    s_mov_b32 s52, 0
    s_mov_b32 s53, 0
    s_waitcnt vmcnt(12)
    v_mfma_f32_16x16x32_bf16 v[32:35], v[144:147], v[16:19], 0
    v_mfma_f32_16x16x32_bf16 v[36:39], v[148:151], v[16:19], 0
    v_mfma_f32_16x16x32_bf16 v[40:43], v[152:155], v[16:19], 0
    v_mfma_f32_16x16x32_bf16 v[44:47], v[156:159], v[16:19], 0
    v_mfma_f32_16x16x32_bf16 v[48:51], v[144:147], v[20:23], 0
    v_mfma_f32_16x16x32_bf16 v[52:55], v[148:151], v[20:23], 0
    v_mfma_f32_16x16x32_bf16 v[56:59], v[152:155], v[20:23], 0
    v_mfma_f32_16x16x32_bf16 v[60:63], v[156:159], v[20:23], 0
    v_mfma_f32_16x16x32_bf16 v[80:83], v[144:147], v[24:27], 0
    v_mfma_f32_16x16x32_bf16 v[84:87], v[148:151], v[24:27], 0
    v_mfma_f32_16x16x32_bf16 v[88:91], v[152:155], v[24:27], 0
    v_mfma_f32_16x16x32_bf16 v[92:95], v[156:159], v[24:27], 0
    v_mfma_f32_16x16x32_bf16 v[96:99], v[144:147], v[28:31], 0
    v_mfma_f32_16x16x32_bf16 v[100:103], v[148:151], v[28:31], 0
    v_mfma_f32_16x16x32_bf16 v[104:107], v[152:155], v[28:31], 0
    v_mfma_f32_16x16x32_bf16 v[108:111], v[156:159], v[28:31], 0
    s_nop 7
    v_max3_f32 v10, v32, v33, v34
    v_max3_f32 v10, v10, v35, v36
    v_max3_f32 v10, v10, v37, v38
    v_max3_f32 v10, v10, v39, v40
    v_max3_f32 v10, v10, v41, v42
    v_max3_f32 v10, v10, v43, v44
    v_max3_f32 v10, v10, v45, v46
    v_max_f32 v10, v10, v47
    v_max3_f32 v11, v48, v49, v50
    v_max3_f32 v11, v11, v51, v52
    v_max3_f32 v11, v11, v53, v54
    v_max3_f32 v11, v11, v55, v56
    v_max3_f32 v11, v11, v57, v58
    v_max3_f32 v11, v11, v59, v60
    v_max3_f32 v11, v11, v61, v62
    v_max_f32 v11, v11, v63
    v_max3_f32 v12, v80, v81, v82
    v_max3_f32 v12, v12, v83, v84
    v_max3_f32 v12, v12, v85, v86
    v_max3_f32 v12, v12, v87, v88
    v_max3_f32 v12, v12, v89, v90
    v_max3_f32 v12, v12, v91, v92
    v_max3_f32 v12, v12, v93, v94
    v_max_f32 v12, v12, v95
    v_max3_f32 v13, v96, v97, v98
    v_max3_f32 v13, v13, v99, v100
    v_max3_f32 v13, v13, v101, v102
    v_max3_f32 v13, v13, v103, v104
    v_max3_f32 v13, v13, v105, v106
    v_max3_f32 v13, v13, v107, v108
    v_max3_f32 v13, v13, v109, v110
    v_max_f32 v13, v13, v111
    ds_swizzle_b32 v5, v10 offset:0x401F
    ds_swizzle_b32 v6, v11 offset:0x401F
    ds_swizzle_b32 v7, v12 offset:0x401F
    ds_swizzle_b32 v8, v13 offset:0x401F
    s_waitcnt lgkmcnt(0)
    v_max_f32 v10, v10, v5
    v_max_f32 v11, v11, v6
    v_max_f32 v12, v12, v7
    v_max_f32 v13, v13, v8
    v_mov_b32 v5, v10
    v_mov_b32 v6, v11
    v_mov_b32 v7, v12
    v_mov_b32 v8, v13
    s_nop 1
    v_permlane32_swap_b32 v10, v5
    v_permlane32_swap_b32 v11, v6
    v_permlane32_swap_b32 v12, v7
    v_permlane32_swap_b32 v13, v8
    s_mov_b32 s54, 0xc2200000
    v_max_f32 v10, v10, v5
    v_sub_f32 v10, s54, v10
    v_mov_b32 v128, v10
    v_mov_b32 v129, v10
    v_mov_b32 v130, v10
    v_mov_b32 v131, v10
    v_max_f32 v11, v11, v6
    v_sub_f32 v11, s54, v11
    v_mov_b32 v132, v11
    v_mov_b32 v133, v11
    v_mov_b32 v134, v11
    v_mov_b32 v135, v11
    v_max_f32 v12, v12, v7
    v_sub_f32 v12, s54, v12
    v_mov_b32 v136, v12
    v_mov_b32 v137, v12
    v_mov_b32 v138, v12
    v_mov_b32 v139, v12
    v_max_f32 v13, v13, v8
    v_sub_f32 v13, s54, v13
    v_mov_b32 v140, v13
    v_mov_b32 v141, v13
    v_mov_b32 v142, v13
    v_mov_b32 v143, v13
    v_mov_b32 v80, 0
    v_mov_b32 v81, 0
    v_mov_b32 v82, 0
    v_mov_b32 v83, 0
    v_mov_b32 v84, 0
    v_mov_b32 v85, 0
    v_mov_b32 v86, 0
    v_mov_b32 v87, 0
    v_mov_b32 v88, 0
    v_mov_b32 v89, 0
    v_mov_b32 v90, 0
    v_mov_b32 v91, 0
    v_mov_b32 v92, 0
    v_mov_b32 v93, 0
    v_mov_b32 v94, 0
    v_mov_b32 v95, 0
    v_mov_b32 v96, 0
    v_mov_b32 v97, 0
    v_mov_b32 v98, 0
    v_mov_b32 v99, 0
    v_mov_b32 v100, 0
    v_mov_b32 v101, 0
    v_mov_b32 v102, 0
    v_mov_b32 v103, 0
    v_mov_b32 v104, 0
    v_mov_b32 v105, 0
    v_mov_b32 v106, 0
    v_mov_b32 v107, 0
    v_mov_b32 v108, 0
    v_mov_b32 v109, 0
    v_mov_b32 v110, 0
    v_mov_b32 v111, 0
    v_mfma_f32_16x16x32_bf16 v[32:35], v[144:147], v[16:19], v[128:131]
    v_mfma_f32_16x16x32_bf16 v[36:39], v[148:151], v[16:19], v[128:131]
    v_mfma_f32_16x16x32_bf16 v[40:43], v[144:147], v[20:23], v[132:135]
    v_mfma_f32_16x16x32_bf16 v[44:47], v[148:151], v[20:23], v[132:135]
    s_nop 7
mix_kernel_a_loop:
    s_waitcnt vmcnt(4)
    s_barrier
    s_mov_b32 m0, s50
    s_nop 0
    buffer_load_dwordx4 v1, s[24:27], s48 offen lds
    s_add_u32 m0, s50, 4096
    s_nop 0
    buffer_load_dwordx4 v1, s[24:27], s49 offen lds
    s_add_u32 s60, s60, 4096
    s_and_b32 s60, s60, 0x1ffff
    s_add_u32 s61, s61, 4096
    s_and_b32 s61, s61, 0x1ffff
    s_add_u32 s48, s46, s60
    s_add_u32 s49, s47, s61
    s_add_u32 s50, s50, 8192
    s_and_b32 s50, s50, 32767
    v_mfma_f32_16x16x32_bf16 v[48:51], v[144:147], v[24:27], v[136:139]
    ds_read_b128 v[152:155], v2 offset:0
    v_exp_f32 v32, v32
    v_exp_f32 v33, v33
    v_mfma_f32_16x16x32_bf16 v[52:55], v[148:151], v[24:27], v[136:139]
    ds_read_b128 v[156:159], v2 offset:256
    v_exp_f32 v34, v34
    v_cvt_pk_bf16_f32 v64, v32, v33
    v_mfma_f32_16x16x32_bf16 v[56:59], v[144:147], v[28:31], v[140:143]
    ds_read_b128 v[160:163], v2 offset:4096
    v_exp_f32 v35, v35
    v_exp_f32 v36, v36
    v_cvt_pk_bf16_f32 v65, v34, v35
    v_mfma_f32_16x16x32_bf16 v[60:63], v[148:151], v[28:31], v[140:143]
    ds_read_b128 v[164:167], v2 offset:4352
    v_exp_f32 v37, v37
    v_exp_f32 v38, v38
    v_mfma_f32_16x16x32_bf16 v[96:99], v[168:171], v[72:75], v[96:99]
    v_cvt_pk_bf16_f32 v66, v36, v37
    v_exp_f32 v39, v39
    v_exp_f32 v40, v40
    v_mfma_f32_16x16x32_bf16 v[100:103], v[172:175], v[72:75], v[100:103]
    v_cvt_pk_bf16_f32 v67, v38, v39
    v_exp_f32 v41, v41
    v_mfma_f32_16x16x32_bf16 v[120:123], v[176:179], v[72:75], v[120:123]
    v_exp_f32 v42, v42
    v_cvt_pk_bf16_f32 v68, v40, v41
    v_exp_f32 v43, v43
    v_mfma_f32_16x16x32_bf16 v[104:107], v[168:171], v[76:79], v[104:107]
    v_exp_f32 v44, v44
    v_cvt_pk_bf16_f32 v69, v42, v43
    v_mfma_f32_16x16x32_bf16 v[108:111], v[172:175], v[76:79], v[108:111]
    v_exp_f32 v45, v45
    v_exp_f32 v46, v46
    v_exp_f32 v47, v47
    v_mfma_f32_16x16x32_bf16 v[124:127], v[176:179], v[76:79], v[124:127]
    v_cvt_pk_bf16_f32 v70, v44, v45
    v_cvt_pk_bf16_f32 v71, v46, v47
    s_waitcnt lgkmcnt(0)
    v_mfma_f32_16x16x32_bf16 v[32:35], v[152:155], v[16:19], v[128:131]
    v_exp_f32 v48, v48
    v_exp_f32 v49, v49
    v_mfma_f32_16x16x32_bf16 v[36:39], v[156:159], v[16:19], v[128:131]
    v_exp_f32 v50, v50
    v_cvt_pk_bf16_f32 v72, v48, v49
    v_mfma_f32_16x16x32_bf16 v[40:43], v[152:155], v[20:23], v[132:135]
    v_exp_f32 v51, v51
    v_exp_f32 v52, v52
    v_cvt_pk_bf16_f32 v73, v50, v51
    v_mfma_f32_16x16x32_bf16 v[44:47], v[156:159], v[20:23], v[132:135]
    v_exp_f32 v53, v53
    v_exp_f32 v54, v54
    v_mfma_f32_16x16x32_bf16 v[80:83], v[160:163], v[64:67], v[80:83]
    v_cvt_pk_bf16_f32 v74, v52, v53
    v_exp_f32 v55, v55
    v_exp_f32 v56, v56
    v_mfma_f32_16x16x32_bf16 v[84:87], v[164:167], v[64:67], v[84:87]
    v_cvt_pk_bf16_f32 v75, v54, v55
    v_exp_f32 v57, v57
    v_mfma_f32_16x16x32_bf16 v[112:115], v[176:179], v[64:67], v[112:115]
    v_exp_f32 v58, v58
    v_cvt_pk_bf16_f32 v76, v56, v57
    v_exp_f32 v59, v59
    v_mfma_f32_16x16x32_bf16 v[88:91], v[160:163], v[68:71], v[88:91]
    v_exp_f32 v60, v60
    v_cvt_pk_bf16_f32 v77, v58, v59
    v_mfma_f32_16x16x32_bf16 v[92:95], v[164:167], v[68:71], v[92:95]
    v_exp_f32 v61, v61
    v_exp_f32 v62, v62
    v_exp_f32 v63, v63
    v_mfma_f32_16x16x32_bf16 v[116:119], v[176:179], v[68:71], v[116:119]
    v_cvt_pk_bf16_f32 v78, v60, v61
    v_cvt_pk_bf16_f32 v79, v62, v63
    v_mfma_f32_16x16x32_bf16 v[48:51], v[152:155], v[24:27], v[136:139]
    ds_read_b128 v[144:147], v2 offset:2048
    v_exp_f32 v32, v32
    v_exp_f32 v33, v33
    v_mfma_f32_16x16x32_bf16 v[52:55], v[156:159], v[24:27], v[136:139]
    ds_read_b128 v[148:151], v2 offset:2304
    v_exp_f32 v34, v34
    v_cvt_pk_bf16_f32 v64, v32, v33
    v_mfma_f32_16x16x32_bf16 v[56:59], v[152:155], v[28:31], v[140:143]
    ds_read_b128 v[168:171], v2 offset:6144
    v_exp_f32 v35, v35
    v_exp_f32 v36, v36
    v_cvt_pk_bf16_f32 v65, v34, v35
    v_mfma_f32_16x16x32_bf16 v[60:63], v[156:159], v[28:31], v[140:143]
    ds_read_b128 v[172:175], v2 offset:6400
    v_exp_f32 v37, v37
    v_exp_f32 v38, v38
    v_mfma_f32_16x16x32_bf16 v[96:99], v[160:163], v[72:75], v[96:99]
    v_cvt_pk_bf16_f32 v66, v36, v37
    v_exp_f32 v39, v39
    v_exp_f32 v40, v40
    v_mfma_f32_16x16x32_bf16 v[100:103], v[164:167], v[72:75], v[100:103]
    v_cvt_pk_bf16_f32 v67, v38, v39
    v_exp_f32 v41, v41
    v_mfma_f32_16x16x32_bf16 v[120:123], v[176:179], v[72:75], v[120:123]
    v_exp_f32 v42, v42
    v_cvt_pk_bf16_f32 v68, v40, v41
    v_exp_f32 v43, v43
    v_mfma_f32_16x16x32_bf16 v[104:107], v[160:163], v[76:79], v[104:107]
    v_exp_f32 v44, v44
    v_cvt_pk_bf16_f32 v69, v42, v43
    v_mfma_f32_16x16x32_bf16 v[108:111], v[164:167], v[76:79], v[108:111]
    v_exp_f32 v45, v45
    v_exp_f32 v46, v46
    v_exp_f32 v47, v47
    v_mfma_f32_16x16x32_bf16 v[124:127], v[176:179], v[76:79], v[124:127]
    v_cvt_pk_bf16_f32 v70, v44, v45
    v_cvt_pk_bf16_f32 v71, v46, v47
    s_waitcnt lgkmcnt(0)
    v_mfma_f32_16x16x32_bf16 v[32:35], v[144:147], v[16:19], v[128:131]
    s_add_u32 s53, s53, 8192
    v_exp_f32 v48, v48
    v_exp_f32 v49, v49
    s_and_b32 s53, s53, 32767
    v_mfma_f32_16x16x32_bf16 v[36:39], v[148:151], v[16:19], v[128:131]
    v_add_u32 v2, s53, v4
    v_exp_f32 v50, v50
    v_cvt_pk_bf16_f32 v72, v48, v49
    v_mfma_f32_16x16x32_bf16 v[40:43], v[144:147], v[20:23], v[132:135]
    v_exp_f32 v51, v51
    v_exp_f32 v52, v52
    v_cvt_pk_bf16_f32 v73, v50, v51
    v_mfma_f32_16x16x32_bf16 v[44:47], v[148:151], v[20:23], v[132:135]
    v_exp_f32 v53, v53
    v_exp_f32 v54, v54
    v_mfma_f32_16x16x32_bf16 v[80:83], v[168:171], v[64:67], v[80:83]
    v_cvt_pk_bf16_f32 v74, v52, v53
    v_exp_f32 v55, v55
    v_exp_f32 v56, v56
    v_mfma_f32_16x16x32_bf16 v[84:87], v[172:175], v[64:67], v[84:87]
    v_cvt_pk_bf16_f32 v75, v54, v55
    v_exp_f32 v57, v57
    v_mfma_f32_16x16x32_bf16 v[112:115], v[176:179], v[64:67], v[112:115]
    v_exp_f32 v58, v58
    v_cvt_pk_bf16_f32 v76, v56, v57
    v_exp_f32 v59, v59
    v_mfma_f32_16x16x32_bf16 v[88:91], v[168:171], v[68:71], v[88:91]
    v_exp_f32 v60, v60
    v_cvt_pk_bf16_f32 v77, v58, v59
    v_mfma_f32_16x16x32_bf16 v[92:95], v[172:175], v[68:71], v[92:95]
    v_exp_f32 v61, v61
    v_exp_f32 v62, v62
    v_exp_f32 v63, v63
    v_mfma_f32_16x16x32_bf16 v[116:119], v[176:179], v[68:71], v[116:119]
    v_cvt_pk_bf16_f32 v78, v60, v61
    v_cvt_pk_bf16_f32 v79, v62, v63
    s_add_u32 s52, s52, 1
    s_cmp_lt_u32 s52, 32
    s_cbranch_scc1 mix_kernel_a_loop
    s_nop 1
    v_mfma_f32_16x16x32_bf16 v[96:99], v[168:171], v[72:75], v[96:99]
    v_mfma_f32_16x16x32_bf16 v[100:103], v[172:175], v[72:75], v[100:103]
    v_mfma_f32_16x16x32_bf16 v[120:123], v[176:179], v[72:75], v[120:123]
    v_mfma_f32_16x16x32_bf16 v[104:107], v[168:171], v[76:79], v[104:107]
    v_mfma_f32_16x16x32_bf16 v[108:111], v[172:175], v[76:79], v[108:111]
    v_mfma_f32_16x16x32_bf16 v[124:127], v[176:179], v[76:79], v[124:127]
    s_nop 7
    s_mov_b32 s54, 0x5d800000
    v_max3_f32 v5, v112, v116, v120
    v_cmp_gt_f32 vcc, s54, v5
    v_cmp_gt_f32 s[56:57], s54, v124
    v_cmp_o_f32 s[58:59], v112, v116
    v_cmp_o_f32 s[64:65], v120, v124
    s_nop 1
    s_and_b64 vcc, vcc, s[56:57]
    s_and_b64 vcc, vcc, s[58:59]
    s_and_b64 vcc, vcc, s[64:65]
    s_cmp_eq_u64 vcc, exec
    s_cbranch_scc0 mix_kernel_a_fallback
mix_kernel_a_final:
    s_lshl_b32 s45, s43, 16
    s_lshl_b32 s46, s42, 11
    s_add_u32 s45, s45, s46
    s_add_u32 s45, s45, 20971520
    v_rcp_f32 v5, v112
    s_nop 0
    v_mul_f32 v80, v80, v5
    v_mul_f32 v81, v81, v5
    v_mul_f32 v82, v82, v5
    v_mul_f32 v83, v83, v5
    v_mul_f32 v84, v84, v5
    v_mul_f32 v85, v85, v5
    v_mul_f32 v86, v86, v5
    v_mul_f32 v87, v87, v5
    v_cvt_pk_bf16_f32 v32, v80, v81
    v_cvt_pk_bf16_f32 v33, v82, v83
    buffer_store_dwordx2 v[32:33], v9, s[24:27], s45 offen offset:0 nt
    v_cvt_pk_bf16_f32 v34, v84, v85
    v_cvt_pk_bf16_f32 v35, v86, v87
    buffer_store_dwordx2 v[34:35], v9, s[24:27], s45 offen offset:1024 nt
    v_rcp_f32 v5, v116
    s_nop 0
    v_mul_f32 v88, v88, v5
    v_mul_f32 v89, v89, v5
    v_mul_f32 v90, v90, v5
    v_mul_f32 v91, v91, v5
    v_mul_f32 v92, v92, v5
    v_mul_f32 v93, v93, v5
    v_mul_f32 v94, v94, v5
    v_mul_f32 v95, v95, v5
    v_cvt_pk_bf16_f32 v36, v88, v89
    v_cvt_pk_bf16_f32 v37, v90, v91
    buffer_store_dwordx2 v[36:37], v9, s[24:27], s45 offen offset:256 nt
    v_cvt_pk_bf16_f32 v38, v92, v93
    v_cvt_pk_bf16_f32 v39, v94, v95
    buffer_store_dwordx2 v[38:39], v9, s[24:27], s45 offen offset:1280 nt
    s_add_u32 s45, s45, 65536
    v_rcp_f32 v5, v120
    s_nop 0
    v_mul_f32 v96, v96, v5
    v_mul_f32 v97, v97, v5
    v_mul_f32 v98, v98, v5
    v_mul_f32 v99, v99, v5
    v_mul_f32 v100, v100, v5
    v_mul_f32 v101, v101, v5
    v_mul_f32 v102, v102, v5
    v_mul_f32 v103, v103, v5
    v_cvt_pk_bf16_f32 v40, v96, v97
    v_cvt_pk_bf16_f32 v41, v98, v99
    buffer_store_dwordx2 v[40:41], v9, s[24:27], s45 offen offset:0 nt
    v_cvt_pk_bf16_f32 v42, v100, v101
    v_cvt_pk_bf16_f32 v43, v102, v103
    buffer_store_dwordx2 v[42:43], v9, s[24:27], s45 offen offset:1024 nt
    v_rcp_f32 v5, v124
    s_nop 0
    v_mul_f32 v104, v104, v5
    v_mul_f32 v105, v105, v5
    v_mul_f32 v106, v106, v5
    v_mul_f32 v107, v107, v5
    v_mul_f32 v108, v108, v5
    v_mul_f32 v109, v109, v5
    v_mul_f32 v110, v110, v5
    v_mul_f32 v111, v111, v5
    v_cvt_pk_bf16_f32 v44, v104, v105
    v_cvt_pk_bf16_f32 v45, v106, v107
    buffer_store_dwordx2 v[44:45], v9, s[24:27], s45 offen offset:256 nt
    v_cvt_pk_bf16_f32 v46, v108, v109
    v_cvt_pk_bf16_f32 v47, v110, v111
    buffer_store_dwordx2 v[46:47], v9, s[24:27], s45 offen offset:1280 nt
    s_waitcnt vmcnt(8)
    v_mov_b32 v64, 0
    v_mov_b32 v65, 0
    v_lshlrev_b32 v66, 16, v208
    v_and_b32 v67, 0xffff0000, v208
    v_lshlrev_b32 v68, 16, v192
    v_and_b32 v69, 0xffff0000, v192
    v_mul_f32 v68, v68, v66
    v_mul_f32 v69, v69, v67
    v_cvt_pk_bf16_f32 v70, v68, v69
    v_lshlrev_b32 v68, 16, v70
    v_and_b32 v69, 0xffff0000, v70
    v_add_f32 v64, v64, v68
    v_add_f32 v64, v64, v69
    v_lshlrev_b32 v68, 16, v200
    v_and_b32 v69, 0xffff0000, v200
    v_mul_f32 v68, v68, v66
    v_mul_f32 v69, v69, v67
    v_cvt_pk_bf16_f32 v70, v68, v69
    v_lshlrev_b32 v68, 16, v70
    v_and_b32 v69, 0xffff0000, v70
    v_add_f32 v65, v65, v68
    v_add_f32 v65, v65, v69
    v_lshlrev_b32 v66, 16, v209
    v_and_b32 v67, 0xffff0000, v209
    v_lshlrev_b32 v68, 16, v193
    v_and_b32 v69, 0xffff0000, v193
    v_mul_f32 v68, v68, v66
    v_mul_f32 v69, v69, v67
    v_cvt_pk_bf16_f32 v70, v68, v69
    v_lshlrev_b32 v68, 16, v70
    v_and_b32 v69, 0xffff0000, v70
    v_add_f32 v64, v64, v68
    v_add_f32 v64, v64, v69
    v_lshlrev_b32 v68, 16, v201
    v_and_b32 v69, 0xffff0000, v201
    v_mul_f32 v68, v68, v66
    v_mul_f32 v69, v69, v67
    v_cvt_pk_bf16_f32 v70, v68, v69
    v_lshlrev_b32 v68, 16, v70
    v_and_b32 v69, 0xffff0000, v70
    v_add_f32 v65, v65, v68
    v_add_f32 v65, v65, v69
    v_lshlrev_b32 v66, 16, v210
    v_and_b32 v67, 0xffff0000, v210
    v_lshlrev_b32 v68, 16, v194
    v_and_b32 v69, 0xffff0000, v194
    v_mul_f32 v68, v68, v66
    v_mul_f32 v69, v69, v67
    v_cvt_pk_bf16_f32 v70, v68, v69
    v_lshlrev_b32 v68, 16, v70
    v_and_b32 v69, 0xffff0000, v70
    v_add_f32 v64, v64, v68
    v_add_f32 v64, v64, v69
    v_lshlrev_b32 v68, 16, v202
    v_and_b32 v69, 0xffff0000, v202
    v_mul_f32 v68, v68, v66
    v_mul_f32 v69, v69, v67
    v_cvt_pk_bf16_f32 v70, v68, v69
    v_lshlrev_b32 v68, 16, v70
    v_and_b32 v69, 0xffff0000, v70
    v_add_f32 v65, v65, v68
    v_add_f32 v65, v65, v69
    v_lshlrev_b32 v66, 16, v211
    v_and_b32 v67, 0xffff0000, v211
    v_lshlrev_b32 v68, 16, v195
    v_and_b32 v69, 0xffff0000, v195
    v_mul_f32 v68, v68, v66
    v_mul_f32 v69, v69, v67
    v_cvt_pk_bf16_f32 v70, v68, v69
    v_lshlrev_b32 v68, 16, v70
    v_and_b32 v69, 0xffff0000, v70
    v_add_f32 v64, v64, v68
    v_add_f32 v64, v64, v69
    v_lshlrev_b32 v68, 16, v203
    v_and_b32 v69, 0xffff0000, v203
    v_mul_f32 v68, v68, v66
    v_mul_f32 v69, v69, v67
    v_cvt_pk_bf16_f32 v70, v68, v69
    v_lshlrev_b32 v68, 16, v70
    v_and_b32 v69, 0xffff0000, v70
    v_add_f32 v65, v65, v68
    v_add_f32 v65, v65, v69
    v_lshlrev_b32 v66, 16, v212
    v_and_b32 v67, 0xffff0000, v212
    v_lshlrev_b32 v68, 16, v196
    v_and_b32 v69, 0xffff0000, v196
    v_mul_f32 v68, v68, v66
    v_mul_f32 v69, v69, v67
    v_cvt_pk_bf16_f32 v70, v68, v69
    v_lshlrev_b32 v68, 16, v70
    v_and_b32 v69, 0xffff0000, v70
    v_add_f32 v64, v64, v68
    v_add_f32 v64, v64, v69
    v_lshlrev_b32 v68, 16, v204
    v_and_b32 v69, 0xffff0000, v204
    v_mul_f32 v68, v68, v66
    v_mul_f32 v69, v69, v67
    v_cvt_pk_bf16_f32 v70, v68, v69
    v_lshlrev_b32 v68, 16, v70
    v_and_b32 v69, 0xffff0000, v70
    v_add_f32 v65, v65, v68
    v_add_f32 v65, v65, v69
    v_lshlrev_b32 v66, 16, v213
    v_and_b32 v67, 0xffff0000, v213
    v_lshlrev_b32 v68, 16, v197
    v_and_b32 v69, 0xffff0000, v197
    v_mul_f32 v68, v68, v66
    v_mul_f32 v69, v69, v67
    v_cvt_pk_bf16_f32 v70, v68, v69
    v_lshlrev_b32 v68, 16, v70
    v_and_b32 v69, 0xffff0000, v70
    v_add_f32 v64, v64, v68
    v_add_f32 v64, v64, v69
    v_lshlrev_b32 v68, 16, v205
    v_and_b32 v69, 0xffff0000, v205
    v_mul_f32 v68, v68, v66
    v_mul_f32 v69, v69, v67
    v_cvt_pk_bf16_f32 v70, v68, v69
    v_lshlrev_b32 v68, 16, v70
    v_and_b32 v69, 0xffff0000, v70
    v_add_f32 v65, v65, v68
    v_add_f32 v65, v65, v69
    v_lshlrev_b32 v66, 16, v214
    v_and_b32 v67, 0xffff0000, v214
    v_lshlrev_b32 v68, 16, v198
    v_and_b32 v69, 0xffff0000, v198
    v_mul_f32 v68, v68, v66
    v_mul_f32 v69, v69, v67
    v_cvt_pk_bf16_f32 v70, v68, v69
    v_lshlrev_b32 v68, 16, v70
    v_and_b32 v69, 0xffff0000, v70
    v_add_f32 v64, v64, v68
    v_add_f32 v64, v64, v69
    v_lshlrev_b32 v68, 16, v206
    v_and_b32 v69, 0xffff0000, v206
    v_mul_f32 v68, v68, v66
    v_mul_f32 v69, v69, v67
    v_cvt_pk_bf16_f32 v70, v68, v69
    v_lshlrev_b32 v68, 16, v70
    v_and_b32 v69, 0xffff0000, v70
    v_add_f32 v65, v65, v68
    v_add_f32 v65, v65, v69
    v_lshlrev_b32 v66, 16, v215
    v_and_b32 v67, 0xffff0000, v215
    v_lshlrev_b32 v68, 16, v199
    v_and_b32 v69, 0xffff0000, v199
    v_mul_f32 v68, v68, v66
    v_mul_f32 v69, v69, v67
    v_cvt_pk_bf16_f32 v70, v68, v69
    v_lshlrev_b32 v68, 16, v70
    v_and_b32 v69, 0xffff0000, v70
    v_add_f32 v64, v64, v68
    v_add_f32 v64, v64, v69
    v_lshlrev_b32 v68, 16, v207
    v_and_b32 v69, 0xffff0000, v207
    v_mul_f32 v68, v68, v66
    v_mul_f32 v69, v69, v67
    v_cvt_pk_bf16_f32 v70, v68, v69
    v_lshlrev_b32 v68, 16, v70
    v_and_b32 v69, 0xffff0000, v70
    v_add_f32 v65, v65, v68
    v_add_f32 v65, v65, v69
    ds_swizzle_b32 v66, v64 offset:1055
    ds_swizzle_b32 v67, v65 offset:1055
    s_waitcnt lgkmcnt(0)
    v_add_f32 v64, v64, v66
    v_add_f32 v65, v65, v67
    ds_swizzle_b32 v66, v64 offset:2079
    ds_swizzle_b32 v67, v65 offset:2079
    s_waitcnt lgkmcnt(0)
    v_add_f32 v64, v64, v66
    v_add_f32 v65, v65, v67
    ds_swizzle_b32 v66, v64 offset:4127
    ds_swizzle_b32 v67, v65 offset:4127
    s_waitcnt lgkmcnt(0)
    v_add_f32 v64, v64, v66
    v_add_f32 v65, v65, v67
    ds_swizzle_b32 v66, v64 offset:8223
    ds_swizzle_b32 v67, v65 offset:8223
    s_waitcnt lgkmcnt(0)
    v_add_f32 v64, v64, v66
    v_add_f32 v65, v65, v67
    ds_swizzle_b32 v66, v64 offset:16415
    ds_swizzle_b32 v67, v65 offset:16415
    s_waitcnt lgkmcnt(0)
    v_add_f32 v64, v64, v66
    v_add_f32 v65, v65, v67
    s_nop 0
    v_readlane_b32 s55, v64, 32
    v_readlane_b32 s56, v65, 32
    s_nop 1
    v_add_f32 v64, s55, v64
    v_add_f32 v65, s56, v65
    v_cmp_eq_u32 vcc, 1, v0
    s_nop 1
    v_cndmask_b32 v64, v64, v65, vcc
    v_cvt_pk_bf16_f32 v64, v64, v64
    v_lshlrev_b32 v64, 16, v64
    v_mul_f32 v64, 0xbfb8aa3b, v64
    v_exp_f32 v64, v64
    s_nop 0
    v_add_f32 v64, 1.0, v64
    v_rcp_f32 v64, v64
    s_nop 0
    v_cvt_pk_bf16_f32 v64, v64, v64
    v_lshlrev_b32 v3, 16, v64
    v_lshlrev_b32 v5, 2, v0
    s_lshl_b32 s45, s62, 2
    s_add_u32 s45, s45, 33554432
    v_cmp_gt_u32 vcc, 2, v0
    s_and_saveexec_b64 s[58:59], vcc
    buffer_store_dword v3, v5, s[24:27], s45 offen
    s_mov_b64 exec, s[58:59]
    s_waitcnt vmcnt(0)
mix_kernel_a_done:
    s_endpgm
mix_kernel_a_fallback:
    s_waitcnt vmcnt(0)
    v_mov_b32 v10, 0xff7fffff
    v_mov_b32 v112, 0
    v_mov_b32 v80, 0
    v_mov_b32 v81, 0
    v_mov_b32 v82, 0
    v_mov_b32 v83, 0
    v_mov_b32 v84, 0
    v_mov_b32 v85, 0
    v_mov_b32 v86, 0
    v_mov_b32 v87, 0
    v_mov_b32 v11, 0xff7fffff
    v_mov_b32 v116, 0
    v_mov_b32 v88, 0
    v_mov_b32 v89, 0
    v_mov_b32 v90, 0
    v_mov_b32 v91, 0
    v_mov_b32 v92, 0
    v_mov_b32 v93, 0
    v_mov_b32 v94, 0
    v_mov_b32 v95, 0
    v_mov_b32 v12, 0xff7fffff
    v_mov_b32 v120, 0
    v_mov_b32 v96, 0
    v_mov_b32 v97, 0
    v_mov_b32 v98, 0
    v_mov_b32 v99, 0
    v_mov_b32 v100, 0
    v_mov_b32 v101, 0
    v_mov_b32 v102, 0
    v_mov_b32 v103, 0
    v_mov_b32 v13, 0xff7fffff
    v_mov_b32 v124, 0
    v_mov_b32 v104, 0
    v_mov_b32 v105, 0
    v_mov_b32 v106, 0
    v_mov_b32 v107, 0
    v_mov_b32 v108, 0
    v_mov_b32 v109, 0
    v_mov_b32 v110, 0
    v_mov_b32 v111, 0
    s_add_u32 s46, s44, 12582912
    s_add_u32 s47, s44, 16777216
    s_mov_b32 s52, 0
mix_kernel_a_fbloop:
    buffer_load_dwordx4 v[144:147], v4, s[24:27], s46 offen
    buffer_load_dwordx4 v[148:151], v4, s[24:27], s46 offen offset:256
    buffer_load_dwordx4 v[160:163], v4, s[24:27], s47 offen
    buffer_load_dwordx4 v[164:167], v4, s[24:27], s47 offen offset:256
    s_waitcnt vmcnt(0)
    v_mfma_f32_16x16x32_bf16 v[32:35], v[144:147], v[16:19], 0
    v_mfma_f32_16x16x32_bf16 v[36:39], v[148:151], v[16:19], 0
    s_nop 7
    v_max3_f32 v5, v32, v33, v10
    v_max3_f32 v5, v5, v34, v35
    v_max3_f32 v5, v5, v36, v37
    v_max3_f32 v5, v5, v38, v39
    ds_swizzle_b32 v6, v5 offset:0x401F
    s_waitcnt lgkmcnt(0)
    v_max_f32 v5, v5, v6
    v_mov_b32 v6, v5
    s_nop 1
    v_permlane32_swap_b32 v5, v6
    v_max_f32 v5, v5, v6
    v_sub_f32 v14, v10, v5
    v_exp_f32 v14, v14
    v_mov_b32 v10, v5
    v_mul_f32 v112, v112, v14
    v_sub_f32 v32, v32, v5
    v_exp_f32 v32, v32
    v_mul_f32 v80, v80, v14
    v_sub_f32 v33, v33, v5
    v_exp_f32 v33, v33
    v_mul_f32 v81, v81, v14
    v_sub_f32 v34, v34, v5
    v_exp_f32 v34, v34
    v_mul_f32 v82, v82, v14
    v_sub_f32 v35, v35, v5
    v_exp_f32 v35, v35
    v_mul_f32 v83, v83, v14
    v_sub_f32 v36, v36, v5
    v_exp_f32 v36, v36
    v_mul_f32 v84, v84, v14
    v_sub_f32 v37, v37, v5
    v_exp_f32 v37, v37
    v_mul_f32 v85, v85, v14
    v_sub_f32 v38, v38, v5
    v_exp_f32 v38, v38
    v_mul_f32 v86, v86, v14
    v_sub_f32 v39, v39, v5
    v_exp_f32 v39, v39
    v_mul_f32 v87, v87, v14
    v_cvt_pk_bf16_f32 v64, v32, v33
    v_lshlrev_b32 v6, 16, v64
    v_and_b32 v7, 0xffff0000, v64
    v_add_f32 v112, v112, v6
    v_add_f32 v112, v112, v7
    v_cvt_pk_bf16_f32 v65, v34, v35
    v_lshlrev_b32 v6, 16, v65
    v_and_b32 v7, 0xffff0000, v65
    v_add_f32 v112, v112, v6
    v_add_f32 v112, v112, v7
    v_cvt_pk_bf16_f32 v66, v36, v37
    v_lshlrev_b32 v6, 16, v66
    v_and_b32 v7, 0xffff0000, v66
    v_add_f32 v112, v112, v6
    v_add_f32 v112, v112, v7
    v_cvt_pk_bf16_f32 v67, v38, v39
    v_lshlrev_b32 v6, 16, v67
    v_and_b32 v7, 0xffff0000, v67
    v_add_f32 v112, v112, v6
    v_add_f32 v112, v112, v7
    s_nop 1
    v_mfma_f32_16x16x32_bf16 v[80:83], v[160:163], v[64:67], v[80:83]
    v_mfma_f32_16x16x32_bf16 v[84:87], v[164:167], v[64:67], v[84:87]
    s_nop 7
    v_mfma_f32_16x16x32_bf16 v[32:35], v[144:147], v[20:23], 0
    v_mfma_f32_16x16x32_bf16 v[36:39], v[148:151], v[20:23], 0
    s_nop 7
    v_max3_f32 v5, v32, v33, v11
    v_max3_f32 v5, v5, v34, v35
    v_max3_f32 v5, v5, v36, v37
    v_max3_f32 v5, v5, v38, v39
    ds_swizzle_b32 v6, v5 offset:0x401F
    s_waitcnt lgkmcnt(0)
    v_max_f32 v5, v5, v6
    v_mov_b32 v6, v5
    s_nop 1
    v_permlane32_swap_b32 v5, v6
    v_max_f32 v5, v5, v6
    v_sub_f32 v14, v11, v5
    v_exp_f32 v14, v14
    v_mov_b32 v11, v5
    v_mul_f32 v116, v116, v14
    v_sub_f32 v32, v32, v5
    v_exp_f32 v32, v32
    v_mul_f32 v88, v88, v14
    v_sub_f32 v33, v33, v5
    v_exp_f32 v33, v33
    v_mul_f32 v89, v89, v14
    v_sub_f32 v34, v34, v5
    v_exp_f32 v34, v34
    v_mul_f32 v90, v90, v14
    v_sub_f32 v35, v35, v5
    v_exp_f32 v35, v35
    v_mul_f32 v91, v91, v14
    v_sub_f32 v36, v36, v5
    v_exp_f32 v36, v36
    v_mul_f32 v92, v92, v14
    v_sub_f32 v37, v37, v5
    v_exp_f32 v37, v37
    v_mul_f32 v93, v93, v14
    v_sub_f32 v38, v38, v5
    v_exp_f32 v38, v38
    v_mul_f32 v94, v94, v14
    v_sub_f32 v39, v39, v5
    v_exp_f32 v39, v39
    v_mul_f32 v95, v95, v14
    v_cvt_pk_bf16_f32 v64, v32, v33
    v_lshlrev_b32 v6, 16, v64
    v_and_b32 v7, 0xffff0000, v64
    v_add_f32 v116, v116, v6
    v_add_f32 v116, v116, v7
    v_cvt_pk_bf16_f32 v65, v34, v35
    v_lshlrev_b32 v6, 16, v65
    v_and_b32 v7, 0xffff0000, v65
    v_add_f32 v116, v116, v6
    v_add_f32 v116, v116, v7
    v_cvt_pk_bf16_f32 v66, v36, v37
    v_lshlrev_b32 v6, 16, v66
    v_and_b32 v7, 0xffff0000, v66
    v_add_f32 v116, v116, v6
    v_add_f32 v116, v116, v7
    v_cvt_pk_bf16_f32 v67, v38, v39
    v_lshlrev_b32 v6, 16, v67
    v_and_b32 v7, 0xffff0000, v67
    v_add_f32 v116, v116, v6
    v_add_f32 v116, v116, v7
    s_nop 1
    v_mfma_f32_16x16x32_bf16 v[88:91], v[160:163], v[64:67], v[88:91]
    v_mfma_f32_16x16x32_bf16 v[92:95], v[164:167], v[64:67], v[92:95]
    s_nop 7
    v_mfma_f32_16x16x32_bf16 v[32:35], v[144:147], v[24:27], 0
    v_mfma_f32_16x16x32_bf16 v[36:39], v[148:151], v[24:27], 0
    s_nop 7
    v_max3_f32 v5, v32, v33, v12
    v_max3_f32 v5, v5, v34, v35
    v_max3_f32 v5, v5, v36, v37
    v_max3_f32 v5, v5, v38, v39
    ds_swizzle_b32 v6, v5 offset:0x401F
    s_waitcnt lgkmcnt(0)
    v_max_f32 v5, v5, v6
    v_mov_b32 v6, v5
    s_nop 1
    v_permlane32_swap_b32 v5, v6
    v_max_f32 v5, v5, v6
    v_sub_f32 v14, v12, v5
    v_exp_f32 v14, v14
    v_mov_b32 v12, v5
    v_mul_f32 v120, v120, v14
    v_sub_f32 v32, v32, v5
    v_exp_f32 v32, v32
    v_mul_f32 v96, v96, v14
    v_sub_f32 v33, v33, v5
    v_exp_f32 v33, v33
    v_mul_f32 v97, v97, v14
    v_sub_f32 v34, v34, v5
    v_exp_f32 v34, v34
    v_mul_f32 v98, v98, v14
    v_sub_f32 v35, v35, v5
    v_exp_f32 v35, v35
    v_mul_f32 v99, v99, v14
    v_sub_f32 v36, v36, v5
    v_exp_f32 v36, v36
    v_mul_f32 v100, v100, v14
    v_sub_f32 v37, v37, v5
    v_exp_f32 v37, v37
    v_mul_f32 v101, v101, v14
    v_sub_f32 v38, v38, v5
    v_exp_f32 v38, v38
    v_mul_f32 v102, v102, v14
    v_sub_f32 v39, v39, v5
    v_exp_f32 v39, v39
    v_mul_f32 v103, v103, v14
    v_cvt_pk_bf16_f32 v64, v32, v33
    v_lshlrev_b32 v6, 16, v64
    v_and_b32 v7, 0xffff0000, v64
    v_add_f32 v120, v120, v6
    v_add_f32 v120, v120, v7
    v_cvt_pk_bf16_f32 v65, v34, v35
    v_lshlrev_b32 v6, 16, v65
    v_and_b32 v7, 0xffff0000, v65
    v_add_f32 v120, v120, v6
    v_add_f32 v120, v120, v7
    v_cvt_pk_bf16_f32 v66, v36, v37
    v_lshlrev_b32 v6, 16, v66
    v_and_b32 v7, 0xffff0000, v66
    v_add_f32 v120, v120, v6
    v_add_f32 v120, v120, v7
    v_cvt_pk_bf16_f32 v67, v38, v39
    v_lshlrev_b32 v6, 16, v67
    v_and_b32 v7, 0xffff0000, v67
    v_add_f32 v120, v120, v6
    v_add_f32 v120, v120, v7
    s_nop 1
    v_mfma_f32_16x16x32_bf16 v[96:99], v[160:163], v[64:67], v[96:99]
    v_mfma_f32_16x16x32_bf16 v[100:103], v[164:167], v[64:67], v[100:103]
    s_nop 7
    v_mfma_f32_16x16x32_bf16 v[32:35], v[144:147], v[28:31], 0
    v_mfma_f32_16x16x32_bf16 v[36:39], v[148:151], v[28:31], 0
    s_nop 7
    v_max3_f32 v5, v32, v33, v13
    v_max3_f32 v5, v5, v34, v35
    v_max3_f32 v5, v5, v36, v37
    v_max3_f32 v5, v5, v38, v39
    ds_swizzle_b32 v6, v5 offset:0x401F
    s_waitcnt lgkmcnt(0)
    v_max_f32 v5, v5, v6
    v_mov_b32 v6, v5
    s_nop 1
    v_permlane32_swap_b32 v5, v6
    v_max_f32 v5, v5, v6
    v_sub_f32 v14, v13, v5
    v_exp_f32 v14, v14
    v_mov_b32 v13, v5
    v_mul_f32 v124, v124, v14
    v_sub_f32 v32, v32, v5
    v_exp_f32 v32, v32
    v_mul_f32 v104, v104, v14
    v_sub_f32 v33, v33, v5
    v_exp_f32 v33, v33
    v_mul_f32 v105, v105, v14
    v_sub_f32 v34, v34, v5
    v_exp_f32 v34, v34
    v_mul_f32 v106, v106, v14
    v_sub_f32 v35, v35, v5
    v_exp_f32 v35, v35
    v_mul_f32 v107, v107, v14
    v_sub_f32 v36, v36, v5
    v_exp_f32 v36, v36
    v_mul_f32 v108, v108, v14
    v_sub_f32 v37, v37, v5
    v_exp_f32 v37, v37
    v_mul_f32 v109, v109, v14
    v_sub_f32 v38, v38, v5
    v_exp_f32 v38, v38
    v_mul_f32 v110, v110, v14
    v_sub_f32 v39, v39, v5
    v_exp_f32 v39, v39
    v_mul_f32 v111, v111, v14
    v_cvt_pk_bf16_f32 v64, v32, v33
    v_lshlrev_b32 v6, 16, v64
    v_and_b32 v7, 0xffff0000, v64
    v_add_f32 v124, v124, v6
    v_add_f32 v124, v124, v7
    v_cvt_pk_bf16_f32 v65, v34, v35
    v_lshlrev_b32 v6, 16, v65
    v_and_b32 v7, 0xffff0000, v65
    v_add_f32 v124, v124, v6
    v_add_f32 v124, v124, v7
    v_cvt_pk_bf16_f32 v66, v36, v37
    v_lshlrev_b32 v6, 16, v66
    v_and_b32 v7, 0xffff0000, v66
    v_add_f32 v124, v124, v6
    v_add_f32 v124, v124, v7
    v_cvt_pk_bf16_f32 v67, v38, v39
    v_lshlrev_b32 v6, 16, v67
    v_and_b32 v7, 0xffff0000, v67
    v_add_f32 v124, v124, v6
    v_add_f32 v124, v124, v7
    s_nop 1
    v_mfma_f32_16x16x32_bf16 v[104:107], v[160:163], v[64:67], v[104:107]
    v_mfma_f32_16x16x32_bf16 v[108:111], v[164:167], v[64:67], v[108:111]
    s_nop 7
    s_add_u32 s46, s46, 2048
    s_add_u32 s47, s47, 2048
    s_add_u32 s52, s52, 1
    s_cmp_lt_u32 s52, 64
    s_cbranch_scc1 mix_kernel_a_fbloop
    ds_swizzle_b32 v6, v112 offset:0x401F
    s_waitcnt lgkmcnt(0)
    v_add_f32 v112, v112, v6
    v_mov_b32 v6, v112
    s_nop 1
    v_permlane32_swap_b32 v112, v6
    v_add_f32 v112, v112, v6
    ds_swizzle_b32 v6, v116 offset:0x401F
    s_waitcnt lgkmcnt(0)
    v_add_f32 v116, v116, v6
    v_mov_b32 v6, v116
    s_nop 1
    v_permlane32_swap_b32 v116, v6
    v_add_f32 v116, v116, v6
    ds_swizzle_b32 v6, v120 offset:0x401F
    s_waitcnt lgkmcnt(0)
    v_add_f32 v120, v120, v6
    v_mov_b32 v6, v120
    s_nop 1
    v_permlane32_swap_b32 v120, v6
    v_add_f32 v120, v120, v6
    ds_swizzle_b32 v6, v124 offset:0x401F
    s_waitcnt lgkmcnt(0)
    v_add_f32 v124, v124, v6
    v_mov_b32 v6, v124
    s_nop 1
    v_permlane32_swap_b32 v124, v6
    v_add_f32 v124, v124, v6
    s_branch mix_kernel_a_final
mix_kernel_ystart:
    s_sub_u32 s3, s3, 4
    s_and_b32 s42, s2, 1
    s_load_dwordx4 s[4:7], s[0:1], 8
    s_load_dwordx2 s[40:41], s[0:1], 88
    s_bfe_u32 s44, s2, 0x10001
    s_lshl_b32 s44, s44, 2
    s_bfe_u32 s45, s2, 0x20003
    s_add_u32 s44, s44, s45
    s_bfe_u32 s45, s2, 0x10002
    s_lshl_b32 s45, s45, 3
    s_lshr_b32 s46, s2, 5
    s_add_u32 s45, s45, s46
    v_lshlrev_b32 v1, 4, v0
    v_lshrrev_b32 v16, 3, v0
    v_and_b32 v17, 7, v0
    v_lshrrev_b32 v18, 4, v0
    s_lshl_b32 s46, s45, 7
    s_lshl_b32 s47, s3, 5
    s_add_u32 s46, s46, s47
    v_add_u32 v19, s46, v16
    v_lshlrev_b32 v19, 12, v19
    v_xor_b32 v2, v17, v18
    v_lshlrev_b32 v2, 4, v2
    v_add_u32 v2, v2, v19
    v_xor_b32 v3, 64, v2
    v_add_u32 v3, 32768, v3
    v_add_u32 v4, 65536, v2
    v_xor_b32 v5, 64, v2
    v_add_u32 v5, 98304, v5
    v_and_b32 v16, 15, v0
    v_lshrrev_b32 v17, 4, v0
    v_and_b32 v18, 1, v17
    v_lshlrev_b32 v18, 5, v18
    v_add_u32 v18, v18, v16
    v_lshlrev_b32 v18, 4, v18
    v_lshrrev_b32 v19, 1, v17
    v_lshlrev_b32 v14, 3, v19
    v_add_u32 v14, v14, v18
    v_lshlrev_b32 v19, 10, v19
    v_add_u32 v18, v18, v19
    s_and_b32 s46, s3, 1
    s_lshl_b32 s46, s46, 13
    s_add_u32 s46, s46, 32768
    v_add_u32 v6, s46, v18
    s_lshr_b32 s46, s3, 1
    s_lshl_b32 s46, s46, 13
    s_add_u32 s46, s46, 49152
    v_lshrrev_b32 v18, 1, v16
    v_xor_b32 v18, v18, v17
    v_lshlrev_b32 v19, 7, v16
    v_add_u32 v19, s46, v19
    v_xor_b32 v16, 0, v18
    v_lshlrev_b32 v16, 4, v16
    v_add_u32 v7, v16, v19
    v_mov_b32 v12, v7
    v_xor_b32 v16, 4, v18
    v_lshlrev_b32 v16, 4, v16
    v_add_u32 v8, v16, v19
    v_mov_b32 v13, v8
    v_mov_b32 v11, v6
    s_waitcnt lgkmcnt(0)
    s_cmp_eq_u32 s42, 0
    s_cselect_b32 s4, s4, s6
    s_cselect_b32 s5, s5, s7
    s_mov_b32 s8, s4
    s_mov_b32 s9, s5
    s_mov_b32 s10, 8388608
    s_mov_b32 s11, 0x00020000
    s_mov_b32 s24, s40
    s_mov_b32 s25, s41
    s_mov_b32 s26, 41943040
    s_mov_b32 s27, 0x00020000
    s_lshl_b32 s47, s44, 2
    s_add_u32 s47, s47, s3
    s_lshl_b32 s47, s47, 17
    s_mul_i32 s46, s42, 4194304
    s_add_u32 s47, s47, s46
    s_mov_b32 s48, 0
    s_lshl_b32 s50, s3, 12
    s_mov_b32 s49, s50
    s_mov_b32 s51, 0
    s_mov_b32 s57, s47
    s_add_u32 m0, s49, 32768
    s_nop 0
    buffer_load_dwordx4 v1, s[24:27], s47 offen lds
    buffer_load_dwordx4 v1, s[24:27], s47 offen offset:1024 lds
    buffer_load_dwordx4 v1, s[24:27], s47 offen offset:2048 lds
    buffer_load_dwordx4 v1, s[24:27], s47 offen offset:3072 lds
    s_add_u32 m0, s49, 49152
    s_nop 0
    buffer_load_dwordx4 v2, s[8:11], s48 offen lds
    s_add_u32 m0, s49, 50176
    s_nop 0
    buffer_load_dwordx4 v3, s[8:11], s48 offen lds
    s_add_u32 m0, s49, 51200
    s_nop 0
    buffer_load_dwordx4 v4, s[8:11], s48 offen lds
    s_add_u32 m0, s49, 52224
    s_nop 0
    buffer_load_dwordx4 v5, s[8:11], s48 offen lds
    s_add_u32 s48, s48, 128
    s_and_b32 s48, s48, 0xfff
    s_lshl_b32 s56, s48, 5
    s_add_u32 s47, s57, s56
    s_add_u32 s49, s49, 32768
    s_and_b32 s49, s49, 131071
    s_add_u32 m0, s49, 32768
    s_nop 0
    buffer_load_dwordx4 v1, s[24:27], s47 offen lds
    buffer_load_dwordx4 v1, s[24:27], s47 offen offset:1024 lds
    buffer_load_dwordx4 v1, s[24:27], s47 offen offset:2048 lds
    buffer_load_dwordx4 v1, s[24:27], s47 offen offset:3072 lds
    s_add_u32 m0, s49, 49152
    s_nop 0
    buffer_load_dwordx4 v2, s[8:11], s48 offen lds
    s_add_u32 m0, s49, 50176
    s_nop 0
    buffer_load_dwordx4 v3, s[8:11], s48 offen lds
    s_add_u32 m0, s49, 51200
    s_nop 0
    buffer_load_dwordx4 v4, s[8:11], s48 offen lds
    s_add_u32 m0, s49, 52224
    s_nop 0
    buffer_load_dwordx4 v5, s[8:11], s48 offen lds
    s_add_u32 s48, s48, 128
    s_and_b32 s48, s48, 0xfff
    s_lshl_b32 s56, s48, 5
    s_add_u32 s47, s57, s56
    s_add_u32 s49, s49, 32768
    s_and_b32 s49, s49, 131071
    v_mov_b32 v72, 0
    v_mov_b32 v73, 0
    v_mov_b32 v74, 0
    v_mov_b32 v75, 0
    v_mov_b32 v76, 0
    v_mov_b32 v77, 0
    v_mov_b32 v78, 0
    v_mov_b32 v79, 0
    v_mov_b32 v80, 0
    v_mov_b32 v81, 0
    v_mov_b32 v82, 0
    v_mov_b32 v83, 0
    v_mov_b32 v84, 0
    v_mov_b32 v85, 0
    v_mov_b32 v86, 0
    v_mov_b32 v87, 0
    v_mov_b32 v88, 0
    v_mov_b32 v89, 0
    v_mov_b32 v90, 0
    v_mov_b32 v91, 0
    v_mov_b32 v92, 0
    v_mov_b32 v93, 0
    v_mov_b32 v94, 0
    v_mov_b32 v95, 0
    v_mov_b32 v96, 0
    v_mov_b32 v97, 0
    v_mov_b32 v98, 0
    v_mov_b32 v99, 0
    v_mov_b32 v100, 0
    v_mov_b32 v101, 0
    v_mov_b32 v102, 0
    v_mov_b32 v103, 0
    v_mov_b32 v104, 0
    v_mov_b32 v105, 0
    v_mov_b32 v106, 0
    v_mov_b32 v107, 0
    v_mov_b32 v108, 0
    v_mov_b32 v109, 0
    v_mov_b32 v110, 0
    v_mov_b32 v111, 0
    v_mov_b32 v112, 0
    v_mov_b32 v113, 0
    v_mov_b32 v114, 0
    v_mov_b32 v115, 0
    v_mov_b32 v116, 0
    v_mov_b32 v117, 0
    v_mov_b32 v118, 0
    v_mov_b32 v119, 0
    v_mov_b32 v120, 0
    v_mov_b32 v121, 0
    v_mov_b32 v122, 0
    v_mov_b32 v123, 0
    v_mov_b32 v124, 0
    v_mov_b32 v125, 0
    v_mov_b32 v126, 0
    v_mov_b32 v127, 0
    v_mov_b32 v128, 0
    v_mov_b32 v129, 0
    v_mov_b32 v130, 0
    v_mov_b32 v131, 0
    v_mov_b32 v132, 0
    v_mov_b32 v133, 0
    v_mov_b32 v134, 0
    v_mov_b32 v135, 0
    s_waitcnt vmcnt(8)
    s_barrier
    ds_read_b128 v[24:27], v11 offset:0
    ds_read_b128 v[40:43], v12 offset:0
    ds_read_b128 v[44:47], v12 offset:2048
    ds_read_b128 v[48:51], v12 offset:4096
    ds_read_b128 v[52:55], v12 offset:6144
    ds_read_b128 v[28:31], v11 offset:256
    s_mov_b32 s52, 0
    s_add_u32 m0, s49, 32768
    s_nop 0
    buffer_load_dwordx4 v1, s[24:27], s47 offen lds
    buffer_load_dwordx4 v1, s[24:27], s47 offen offset:1024 lds
    buffer_load_dwordx4 v1, s[24:27], s47 offen offset:2048 lds
    buffer_load_dwordx4 v1, s[24:27], s47 offen offset:3072 lds
    s_add_u32 m0, s49, 49152
    s_nop 0
    buffer_load_dwordx4 v2, s[8:11], s48 offen lds
    s_add_u32 m0, s49, 50176
    s_nop 0
    buffer_load_dwordx4 v3, s[8:11], s48 offen lds
    s_add_u32 m0, s49, 51200
    s_nop 0
    buffer_load_dwordx4 v4, s[8:11], s48 offen lds
    s_add_u32 m0, s49, 52224
    s_nop 0
    buffer_load_dwordx4 v5, s[8:11], s48 offen lds
    s_add_u32 s48, s48, 128
    s_and_b32 s48, s48, 0xfff
    s_lshl_b32 s56, s48, 5
    s_add_u32 s47, s57, s56
    s_add_u32 s49, s49, 32768
    s_and_b32 s49, s49, 131071
mix_kernel_y_loop:
    s_waitcnt lgkmcnt(0)
    v_mfma_f32_16x16x32_bf16 v[72:75], v[24:27], v[40:43], v[72:75]
    s_add_u32 m0, s49, 32768
    v_mfma_f32_16x16x32_bf16 v[76:79], v[24:27], v[44:47], v[76:79]
    ds_read_b128 v[32:35], v11 offset:4096
    v_mfma_f32_16x16x32_bf16 v[80:83], v[24:27], v[48:51], v[80:83]
    buffer_load_dwordx4 v1, s[24:27], s47 offen lds
    v_mfma_f32_16x16x32_bf16 v[84:87], v[24:27], v[52:55], v[84:87]
    ds_read_b128 v[36:39], v11 offset:4352
    v_mfma_f32_16x16x32_bf16 v[88:91], v[28:31], v[40:43], v[88:91]
    buffer_load_dwordx4 v1, s[24:27], s47 offen offset:1024 lds
    v_mfma_f32_16x16x32_bf16 v[92:95], v[28:31], v[44:47], v[92:95]
    buffer_load_dwordx4 v1, s[24:27], s47 offen offset:2048 lds
    v_mfma_f32_16x16x32_bf16 v[96:99], v[28:31], v[48:51], v[96:99]
    buffer_load_dwordx4 v1, s[24:27], s47 offen offset:3072 lds
    v_mfma_f32_16x16x32_bf16 v[100:103], v[28:31], v[52:55], v[100:103]
    s_waitcnt lgkmcnt(0)
    v_mfma_f32_16x16x32_bf16 v[104:107], v[32:35], v[40:43], v[104:107]
    s_add_u32 m0, s49, 49152
    ds_read_b128 v[24:27], v11 offset:2048
    buffer_load_dwordx4 v2, s[8:11], s48 offen lds
    v_mfma_f32_16x16x32_bf16 v[108:111], v[32:35], v[44:47], v[108:111]
    s_add_u32 m0, s49, 50176
    ds_read_b128 v[56:59], v13 offset:0
    v_mfma_f32_16x16x32_bf16 v[112:115], v[32:35], v[48:51], v[112:115]
    buffer_load_dwordx4 v3, s[8:11], s48 offen lds
    s_add_u32 m0, s49, 51200
    ds_read_b128 v[60:63], v13 offset:2048
    v_mfma_f32_16x16x32_bf16 v[116:119], v[32:35], v[52:55], v[116:119]
    buffer_load_dwordx4 v4, s[8:11], s48 offen lds
    s_add_u32 m0, s49, 52224
    v_mfma_f32_16x16x32_bf16 v[120:123], v[36:39], v[40:43], v[120:123]
    ds_read_b128 v[64:67], v13 offset:4096
    buffer_load_dwordx4 v5, s[8:11], s48 offen lds
    ds_read_b128 v[68:71], v13 offset:6144
    v_mfma_f32_16x16x32_bf16 v[124:127], v[36:39], v[44:47], v[124:127]
    ds_read_b128 v[28:31], v11 offset:2304
    s_add_u32 s48, s48, 128
    v_mfma_f32_16x16x32_bf16 v[128:131], v[36:39], v[48:51], v[128:131]
    s_and_b32 s48, s48, 0xfff
    s_lshl_b32 s56, s48, 5
    s_add_u32 s47, s57, s56
    v_mfma_f32_16x16x32_bf16 v[132:135], v[36:39], v[52:55], v[132:135]
    s_add_u32 s49, s49, 32768
    s_and_b32 s49, s49, 131071
    s_waitcnt lgkmcnt(0)
    v_mfma_f32_16x16x32_bf16 v[72:75], v[24:27], v[56:59], v[72:75]
    ds_read_b128 v[32:35], v11 offset:6144
    v_mfma_f32_16x16x32_bf16 v[76:79], v[24:27], v[60:63], v[76:79]
    ds_read_b128 v[36:39], v11 offset:6400
    v_mfma_f32_16x16x32_bf16 v[80:83], v[24:27], v[64:67], v[80:83]
    s_add_u32 s51, s51, 32768
    v_mfma_f32_16x16x32_bf16 v[84:87], v[24:27], v[68:71], v[84:87]
    s_and_b32 s51, s51, 131071
    v_mfma_f32_16x16x32_bf16 v[88:91], v[28:31], v[56:59], v[88:91]
    v_add_u32 v11, s51, v6
    v_mfma_f32_16x16x32_bf16 v[92:95], v[28:31], v[60:63], v[92:95]
    v_add_u32 v12, s51, v7
    v_mfma_f32_16x16x32_bf16 v[96:99], v[28:31], v[64:67], v[96:99]
    v_add_u32 v13, s51, v8
    v_mfma_f32_16x16x32_bf16 v[100:103], v[28:31], v[68:71], v[100:103]
    s_waitcnt lgkmcnt(0)
    v_mfma_f32_16x16x32_bf16 v[104:107], v[32:35], v[56:59], v[104:107]
    v_mfma_f32_16x16x32_bf16 v[108:111], v[32:35], v[60:63], v[108:111]
    s_waitcnt vmcnt(16)
    s_barrier
    v_mfma_f32_16x16x32_bf16 v[112:115], v[32:35], v[64:67], v[112:115]
    ds_read_b128 v[24:27], v11 offset:0
    v_mfma_f32_16x16x32_bf16 v[116:119], v[32:35], v[68:71], v[116:119]
    ds_read_b128 v[40:43], v12 offset:0
    v_mfma_f32_16x16x32_bf16 v[120:123], v[36:39], v[56:59], v[120:123]
    ds_read_b128 v[44:47], v12 offset:2048
    v_mfma_f32_16x16x32_bf16 v[124:127], v[36:39], v[60:63], v[124:127]
    ds_read_b128 v[48:51], v12 offset:4096
    v_mfma_f32_16x16x32_bf16 v[128:131], v[36:39], v[64:67], v[128:131]
    ds_read_b128 v[52:55], v12 offset:6144
    v_mfma_f32_16x16x32_bf16 v[132:135], v[36:39], v[68:71], v[132:135]
    ds_read_b128 v[28:31], v11 offset:256
    s_add_u32 s52, s52, 1
    s_cmp_lt_u32 s52, 29
    s_cbranch_scc1 mix_kernel_y_loop
    s_waitcnt lgkmcnt(0)
    v_mfma_f32_16x16x32_bf16 v[72:75], v[24:27], v[40:43], v[72:75]
    ds_read_b128 v[32:35], v11 offset:4096
    v_mfma_f32_16x16x32_bf16 v[76:79], v[24:27], v[44:47], v[76:79]
    v_mfma_f32_16x16x32_bf16 v[80:83], v[24:27], v[48:51], v[80:83]
    v_mfma_f32_16x16x32_bf16 v[84:87], v[24:27], v[52:55], v[84:87]
    v_mfma_f32_16x16x32_bf16 v[88:91], v[28:31], v[40:43], v[88:91]
    ds_read_b128 v[36:39], v11 offset:4352
    v_mfma_f32_16x16x32_bf16 v[92:95], v[28:31], v[44:47], v[92:95]
    v_mfma_f32_16x16x32_bf16 v[96:99], v[28:31], v[48:51], v[96:99]
    v_mfma_f32_16x16x32_bf16 v[100:103], v[28:31], v[52:55], v[100:103]
    s_waitcnt lgkmcnt(0)
    v_mfma_f32_16x16x32_bf16 v[104:107], v[32:35], v[40:43], v[104:107]
    ds_read_b128 v[24:27], v11 offset:2048
    v_mfma_f32_16x16x32_bf16 v[108:111], v[32:35], v[44:47], v[108:111]
    ds_read_b128 v[56:59], v13 offset:0
    v_mfma_f32_16x16x32_bf16 v[112:115], v[32:35], v[48:51], v[112:115]
    ds_read_b128 v[60:63], v13 offset:2048
    v_mfma_f32_16x16x32_bf16 v[116:119], v[32:35], v[52:55], v[116:119]
    v_mfma_f32_16x16x32_bf16 v[120:123], v[36:39], v[40:43], v[120:123]
    ds_read_b128 v[64:67], v13 offset:4096
    v_mfma_f32_16x16x32_bf16 v[124:127], v[36:39], v[44:47], v[124:127]
    ds_read_b128 v[68:71], v13 offset:6144
    v_mfma_f32_16x16x32_bf16 v[128:131], v[36:39], v[48:51], v[128:131]
    ds_read_b128 v[28:31], v11 offset:2304
    v_mfma_f32_16x16x32_bf16 v[132:135], v[36:39], v[52:55], v[132:135]
    s_waitcnt lgkmcnt(0)
    v_mfma_f32_16x16x32_bf16 v[72:75], v[24:27], v[56:59], v[72:75]
    ds_read_b128 v[32:35], v11 offset:6144
    v_mfma_f32_16x16x32_bf16 v[76:79], v[24:27], v[60:63], v[76:79]
    ds_read_b128 v[36:39], v11 offset:6400
    v_mfma_f32_16x16x32_bf16 v[80:83], v[24:27], v[64:67], v[80:83]
    s_add_u32 s51, s51, 32768
    v_mfma_f32_16x16x32_bf16 v[84:87], v[24:27], v[68:71], v[84:87]
    s_and_b32 s51, s51, 131071
    v_mfma_f32_16x16x32_bf16 v[88:91], v[28:31], v[56:59], v[88:91]
    v_add_u32 v11, s51, v6
    v_mfma_f32_16x16x32_bf16 v[92:95], v[28:31], v[60:63], v[92:95]
    v_add_u32 v12, s51, v7
    v_mfma_f32_16x16x32_bf16 v[96:99], v[28:31], v[64:67], v[96:99]
    v_add_u32 v13, s51, v8
    v_mfma_f32_16x16x32_bf16 v[100:103], v[28:31], v[68:71], v[100:103]
    s_waitcnt lgkmcnt(0)
    v_mfma_f32_16x16x32_bf16 v[104:107], v[32:35], v[56:59], v[104:107]
    v_mfma_f32_16x16x32_bf16 v[108:111], v[32:35], v[60:63], v[108:111]
    s_waitcnt vmcnt(8)
    s_barrier
    v_mfma_f32_16x16x32_bf16 v[112:115], v[32:35], v[64:67], v[112:115]
    ds_read_b128 v[24:27], v11 offset:0
    v_mfma_f32_16x16x32_bf16 v[116:119], v[32:35], v[68:71], v[116:119]
    ds_read_b128 v[40:43], v12 offset:0
    v_mfma_f32_16x16x32_bf16 v[120:123], v[36:39], v[56:59], v[120:123]
    ds_read_b128 v[44:47], v12 offset:2048
    v_mfma_f32_16x16x32_bf16 v[124:127], v[36:39], v[60:63], v[124:127]
    ds_read_b128 v[48:51], v12 offset:4096
    v_mfma_f32_16x16x32_bf16 v[128:131], v[36:39], v[64:67], v[128:131]
    ds_read_b128 v[52:55], v12 offset:6144
    v_mfma_f32_16x16x32_bf16 v[132:135], v[36:39], v[68:71], v[132:135]
    ds_read_b128 v[28:31], v11 offset:256
    s_waitcnt lgkmcnt(0)
    v_mfma_f32_16x16x32_bf16 v[72:75], v[24:27], v[40:43], v[72:75]
    ds_read_b128 v[32:35], v11 offset:4096
    v_mfma_f32_16x16x32_bf16 v[76:79], v[24:27], v[44:47], v[76:79]
    v_mfma_f32_16x16x32_bf16 v[80:83], v[24:27], v[48:51], v[80:83]
    v_mfma_f32_16x16x32_bf16 v[84:87], v[24:27], v[52:55], v[84:87]
    v_mfma_f32_16x16x32_bf16 v[88:91], v[28:31], v[40:43], v[88:91]
    ds_read_b128 v[36:39], v11 offset:4352
    v_mfma_f32_16x16x32_bf16 v[92:95], v[28:31], v[44:47], v[92:95]
    v_mfma_f32_16x16x32_bf16 v[96:99], v[28:31], v[48:51], v[96:99]
    v_mfma_f32_16x16x32_bf16 v[100:103], v[28:31], v[52:55], v[100:103]
    s_waitcnt lgkmcnt(0)
    v_mfma_f32_16x16x32_bf16 v[104:107], v[32:35], v[40:43], v[104:107]
    ds_read_b128 v[24:27], v11 offset:2048
    v_mfma_f32_16x16x32_bf16 v[108:111], v[32:35], v[44:47], v[108:111]
    ds_read_b128 v[56:59], v13 offset:0
    v_mfma_f32_16x16x32_bf16 v[112:115], v[32:35], v[48:51], v[112:115]
    ds_read_b128 v[60:63], v13 offset:2048
    v_mfma_f32_16x16x32_bf16 v[116:119], v[32:35], v[52:55], v[116:119]
    v_mfma_f32_16x16x32_bf16 v[120:123], v[36:39], v[40:43], v[120:123]
    ds_read_b128 v[64:67], v13 offset:4096
    v_mfma_f32_16x16x32_bf16 v[124:127], v[36:39], v[44:47], v[124:127]
    ds_read_b128 v[68:71], v13 offset:6144
    v_mfma_f32_16x16x32_bf16 v[128:131], v[36:39], v[48:51], v[128:131]
    ds_read_b128 v[28:31], v11 offset:2304
    v_mfma_f32_16x16x32_bf16 v[132:135], v[36:39], v[52:55], v[132:135]
    s_waitcnt lgkmcnt(0)
    v_mfma_f32_16x16x32_bf16 v[72:75], v[24:27], v[56:59], v[72:75]
    ds_read_b128 v[32:35], v11 offset:6144
    v_mfma_f32_16x16x32_bf16 v[76:79], v[24:27], v[60:63], v[76:79]
    ds_read_b128 v[36:39], v11 offset:6400
    v_mfma_f32_16x16x32_bf16 v[80:83], v[24:27], v[64:67], v[80:83]
    s_add_u32 s51, s51, 32768
    v_mfma_f32_16x16x32_bf16 v[84:87], v[24:27], v[68:71], v[84:87]
    s_and_b32 s51, s51, 131071
    v_mfma_f32_16x16x32_bf16 v[88:91], v[28:31], v[56:59], v[88:91]
    v_add_u32 v11, s51, v6
    v_mfma_f32_16x16x32_bf16 v[92:95], v[28:31], v[60:63], v[92:95]
    v_add_u32 v12, s51, v7
    v_mfma_f32_16x16x32_bf16 v[96:99], v[28:31], v[64:67], v[96:99]
    v_add_u32 v13, s51, v8
    v_mfma_f32_16x16x32_bf16 v[100:103], v[28:31], v[68:71], v[100:103]
    s_waitcnt lgkmcnt(0)
    v_mfma_f32_16x16x32_bf16 v[104:107], v[32:35], v[56:59], v[104:107]
    v_mfma_f32_16x16x32_bf16 v[108:111], v[32:35], v[60:63], v[108:111]
    s_waitcnt vmcnt(0)
    s_barrier
    v_mfma_f32_16x16x32_bf16 v[112:115], v[32:35], v[64:67], v[112:115]
    ds_read_b128 v[24:27], v11 offset:0
    v_mfma_f32_16x16x32_bf16 v[116:119], v[32:35], v[68:71], v[116:119]
    ds_read_b128 v[40:43], v12 offset:0
    v_mfma_f32_16x16x32_bf16 v[120:123], v[36:39], v[56:59], v[120:123]
    ds_read_b128 v[44:47], v12 offset:2048
    v_mfma_f32_16x16x32_bf16 v[124:127], v[36:39], v[60:63], v[124:127]
    ds_read_b128 v[48:51], v12 offset:4096
    v_mfma_f32_16x16x32_bf16 v[128:131], v[36:39], v[64:67], v[128:131]
    ds_read_b128 v[52:55], v12 offset:6144
    v_mfma_f32_16x16x32_bf16 v[132:135], v[36:39], v[68:71], v[132:135]
    ds_read_b128 v[28:31], v11 offset:256
    s_waitcnt lgkmcnt(0)
    v_mfma_f32_16x16x32_bf16 v[72:75], v[24:27], v[40:43], v[72:75]
    ds_read_b128 v[32:35], v11 offset:4096
    v_mfma_f32_16x16x32_bf16 v[76:79], v[24:27], v[44:47], v[76:79]
    v_mfma_f32_16x16x32_bf16 v[80:83], v[24:27], v[48:51], v[80:83]
    v_mfma_f32_16x16x32_bf16 v[84:87], v[24:27], v[52:55], v[84:87]
    v_mfma_f32_16x16x32_bf16 v[88:91], v[28:31], v[40:43], v[88:91]
    ds_read_b128 v[36:39], v11 offset:4352
    v_mfma_f32_16x16x32_bf16 v[92:95], v[28:31], v[44:47], v[92:95]
    v_mfma_f32_16x16x32_bf16 v[96:99], v[28:31], v[48:51], v[96:99]
    v_mfma_f32_16x16x32_bf16 v[100:103], v[28:31], v[52:55], v[100:103]
    s_waitcnt lgkmcnt(0)
    v_mfma_f32_16x16x32_bf16 v[104:107], v[32:35], v[40:43], v[104:107]
    ds_read_b128 v[24:27], v11 offset:2048
    v_mfma_f32_16x16x32_bf16 v[108:111], v[32:35], v[44:47], v[108:111]
    ds_read_b128 v[56:59], v13 offset:0
    v_mfma_f32_16x16x32_bf16 v[112:115], v[32:35], v[48:51], v[112:115]
    ds_read_b128 v[60:63], v13 offset:2048
    v_mfma_f32_16x16x32_bf16 v[116:119], v[32:35], v[52:55], v[116:119]
    v_mfma_f32_16x16x32_bf16 v[120:123], v[36:39], v[40:43], v[120:123]
    ds_read_b128 v[64:67], v13 offset:4096
    v_mfma_f32_16x16x32_bf16 v[124:127], v[36:39], v[44:47], v[124:127]
    ds_read_b128 v[68:71], v13 offset:6144
    v_mfma_f32_16x16x32_bf16 v[128:131], v[36:39], v[48:51], v[128:131]
    ds_read_b128 v[28:31], v11 offset:2304
    v_mfma_f32_16x16x32_bf16 v[132:135], v[36:39], v[52:55], v[132:135]
    s_waitcnt lgkmcnt(0)
    v_mfma_f32_16x16x32_bf16 v[72:75], v[24:27], v[56:59], v[72:75]
    ds_read_b128 v[32:35], v11 offset:6144
    v_mfma_f32_16x16x32_bf16 v[76:79], v[24:27], v[60:63], v[76:79]
    v_mfma_f32_16x16x32_bf16 v[80:83], v[24:27], v[64:67], v[80:83]
    v_mfma_f32_16x16x32_bf16 v[84:87], v[24:27], v[68:71], v[84:87]
    v_mfma_f32_16x16x32_bf16 v[88:91], v[28:31], v[56:59], v[88:91]
    ds_read_b128 v[36:39], v11 offset:6400
    v_mfma_f32_16x16x32_bf16 v[92:95], v[28:31], v[60:63], v[92:95]
    v_mfma_f32_16x16x32_bf16 v[96:99], v[28:31], v[64:67], v[96:99]
    v_mfma_f32_16x16x32_bf16 v[100:103], v[28:31], v[68:71], v[100:103]
    s_waitcnt lgkmcnt(0)
    v_mfma_f32_16x16x32_bf16 v[104:107], v[32:35], v[56:59], v[104:107]
    v_mfma_f32_16x16x32_bf16 v[108:111], v[32:35], v[60:63], v[108:111]
    v_mfma_f32_16x16x32_bf16 v[112:115], v[32:35], v[64:67], v[112:115]
    v_mfma_f32_16x16x32_bf16 v[116:119], v[32:35], v[68:71], v[116:119]
    v_mfma_f32_16x16x32_bf16 v[120:123], v[36:39], v[56:59], v[120:123]
    v_mfma_f32_16x16x32_bf16 v[124:127], v[36:39], v[60:63], v[124:127]
    v_mfma_f32_16x16x32_bf16 v[128:131], v[36:39], v[64:67], v[128:131]
    v_mfma_f32_16x16x32_bf16 v[132:135], v[36:39], v[68:71], v[132:135]
    s_nop 15
    s_lshl_b32 s46, s44, 2
    s_and_b32 s47, s3, 1
    s_lshl_b32 s47, s47, 1
    s_add_u32 s46, s46, s47
    s_lshl_b32 s46, s46, 17
    s_lshl_b32 s47, s45, 2
    s_lshr_b32 s48, s3, 1
    s_lshl_b32 s48, s48, 1
    s_add_u32 s47, s47, s48
    s_lshl_b32 s47, s47, 11
    s_add_u32 s46, s46, s47
    s_mul_i32 s47, s42, 4194304
    s_add_u32 s46, s46, s47
    s_add_u32 s46, s46, 25165824
    v_cvt_pk_bf16_f32 v24, v72, v73
    v_cvt_pk_bf16_f32 v25, v74, v75
    buffer_store_dwordx2 v[24:25], v14, s[24:27], s46 offen offset:0 nt
    v_cvt_pk_bf16_f32 v26, v76, v77
    v_cvt_pk_bf16_f32 v27, v78, v79
    buffer_store_dwordx2 v[26:27], v14, s[24:27], s46 offen offset:256 nt
    v_cvt_pk_bf16_f32 v28, v80, v81
    v_cvt_pk_bf16_f32 v29, v82, v83
    buffer_store_dwordx2 v[28:29], v14, s[24:27], s46 offen offset:2048 nt
    v_cvt_pk_bf16_f32 v30, v84, v85
    v_cvt_pk_bf16_f32 v31, v86, v87
    buffer_store_dwordx2 v[30:31], v14, s[24:27], s46 offen offset:2304 nt
    v_cvt_pk_bf16_f32 v32, v88, v89
    v_cvt_pk_bf16_f32 v33, v90, v91
    buffer_store_dwordx2 v[32:33], v14, s[24:27], s46 offen offset:1024 nt
    v_cvt_pk_bf16_f32 v34, v92, v93
    v_cvt_pk_bf16_f32 v35, v94, v95
    buffer_store_dwordx2 v[34:35], v14, s[24:27], s46 offen offset:1280 nt
    v_cvt_pk_bf16_f32 v36, v96, v97
    v_cvt_pk_bf16_f32 v37, v98, v99
    buffer_store_dwordx2 v[36:37], v14, s[24:27], s46 offen offset:3072 nt
    v_cvt_pk_bf16_f32 v38, v100, v101
    v_cvt_pk_bf16_f32 v39, v102, v103
    buffer_store_dwordx2 v[38:39], v14, s[24:27], s46 offen offset:3328 nt
    s_add_u32 s46, s46, 131072
    v_cvt_pk_bf16_f32 v40, v104, v105
    v_cvt_pk_bf16_f32 v41, v106, v107
    buffer_store_dwordx2 v[40:41], v14, s[24:27], s46 offen offset:0 nt
    v_cvt_pk_bf16_f32 v42, v108, v109
    v_cvt_pk_bf16_f32 v43, v110, v111
    buffer_store_dwordx2 v[42:43], v14, s[24:27], s46 offen offset:256 nt
    v_cvt_pk_bf16_f32 v44, v112, v113
    v_cvt_pk_bf16_f32 v45, v114, v115
    buffer_store_dwordx2 v[44:45], v14, s[24:27], s46 offen offset:2048 nt
    v_cvt_pk_bf16_f32 v46, v116, v117
    v_cvt_pk_bf16_f32 v47, v118, v119
    buffer_store_dwordx2 v[46:47], v14, s[24:27], s46 offen offset:2304 nt
    v_cvt_pk_bf16_f32 v48, v120, v121
    v_cvt_pk_bf16_f32 v49, v122, v123
    buffer_store_dwordx2 v[48:49], v14, s[24:27], s46 offen offset:1024 nt
    v_cvt_pk_bf16_f32 v50, v124, v125
    v_cvt_pk_bf16_f32 v51, v126, v127
    buffer_store_dwordx2 v[50:51], v14, s[24:27], s46 offen offset:1280 nt
    v_cvt_pk_bf16_f32 v52, v128, v129
    v_cvt_pk_bf16_f32 v53, v130, v131
    buffer_store_dwordx2 v[52:53], v14, s[24:27], s46 offen offset:3072 nt
    v_cvt_pk_bf16_f32 v54, v132, v133
    v_cvt_pk_bf16_f32 v55, v134, v135
    buffer_store_dwordx2 v[54:55], v14, s[24:27], s46 offen offset:3328 nt
mix_kernel_y_done:
    s_endpgm
.globl out_kernel
.p2align 8
.type out_kernel,@function
out_kernel:
    s_cmp_ge_u32 s2, 256
    s_cbranch_scc1 out_kernel_done
    s_load_dwordx2 s[4:5], s[0:1], 56
    s_load_dwordx2 s[6:7], s[0:1], 72
    s_load_dwordx2 s[40:41], s[0:1], 88
    v_lshrrev_b32 v1, 6, v0
    v_and_b32 v0, 63, v0
    v_readfirstlane_b32 s3, v1
    s_and_b32 s45, s2, 3
    s_lshl_b32 s45, s45, 2
    s_bfe_u32 s46, s2, 0x20003
    s_add_u32 s45, s45, s46
    s_bfe_u32 s44, s2, 0x10002
    s_lshl_b32 s44, s44, 3
    s_lshr_b32 s46, s2, 5
    s_add_u32 s44, s44, s46
    s_lshl_b32 s43, s45, 2
    s_add_u32 s43, s43, s3
    v_lshlrev_b32 v1, 4, v0
    v_lshrrev_b32 v19, 3, v0
    s_lshl_b32 s46, s3, 4
    v_add_u32 v19, s46, v19
    v_lshlrev_b32 v19, 11, v19
    v_bfe_u32 v16, v0, 4, 1
    v_lshlrev_b32 v16, 2, v16
    v_and_b32 v17, 7, v0
    v_xor_b32 v16, v16, v17
    v_lshlrev_b32 v2, 4, v16
    v_add_u32 v2, v2, v19
    s_lshl_b32 s46, s44, 7
    v_add_u32 v2, s46, v2
    v_add_u32 v3, 16384, v2
    v_lshrrev_b32 v16, 5, v0
    v_lshlrev_b32 v16, 2, v16
    v_bfe_u32 v17, v0, 2, 2
    v_add_u32 v16, v16, v17
    v_lshlrev_b32 v16, 7, v16
    v_bfe_u32 v17, v0, 3, 1
    v_lshlrev_b32 v17, 6, v17
    v_add_u32 v16, v16, v17
    v_bfe_u32 v17, v0, 4, 1
    v_lshlrev_b32 v17, 5, v17
    v_add_u32 v16, v16, v17
    v_and_b32 v17, 3, v0
    v_lshlrev_b32 v17, 3, v17
    v_add_u32 v4, v16, v17
    v_xor_b32 v10, 64, v4
    s_lshl_b32 s50, s3, 12
    s_add_u32 s46, s50, 8192
    v_add_u32 v5, s46, v1
    v_mov_b32 v6, v4
    v_mov_b32 v11, v10
    v_mov_b32 v7, v5
    v_and_b32 v16, 31, v0
    s_lshl_b32 s46, s43, 5
    v_add_u32 v17, s46, v16
    v_lshlrev_b32 v9, 11, v17
    v_lshrrev_b32 v18, 5, v0
    v_lshlrev_b32 v18, 4, v18
    v_add_u32 v9, v9, v18
    s_lshl_b32 s46, s44, 7
    v_add_u32 v9, s46, v9
    v_lshlrev_b32 v17, 2, v17
    s_waitcnt lgkmcnt(0)
    s_mov_b32 s8, s4
    s_mov_b32 s9, s5
    s_mov_b32 s10, 2097152
    s_mov_b32 s11, 0x00020000
    s_mov_b32 s12, s6
    s_mov_b32 s13, s7
    s_mov_b32 s14, 4194304
    s_mov_b32 s15, 0x00020000
    s_mov_b32 s24, s40
    s_mov_b32 s25, s41
    s_mov_b32 s26, 41943040
    s_mov_b32 s27, 0x00020000
    s_lshl_b32 s47, s43, 16
    s_add_u32 s47, s47, 20971520
    s_mov_b32 s48, 0
    s_mov_b32 s49, 0
    s_lshl_b32 s53, s3, 11
    s_mov_b32 s51, 0
    s_add_u32 s54, s50, 8192
    s_lshr_b32 s56, s2, 5
    s_lshl_b32 s56, s56, 1
    s_bfe_u32 s57, s2, 0x20003
    s_lshl_b32 s57, s57, 2
    s_add_u32 s56, s56, s57
    s_and_b32 s56, s56, 15
    s_lshl_b32 s56, s56, 12
    s_mov_b32 s57, s47
    s_add_u32 s47, s57, s56
    s_lshl_b32 s48, s56, 5
    s_add_u32 m0, s49, s53
    s_nop 0
    buffer_load_dwordx4 v2, s[8:11], s48 offen lds
    s_add_u32 m0, m0, 1024
    s_nop 0
    buffer_load_dwordx4 v3, s[8:11], s48 offen lds
    s_add_u32 m0, s49, s54
    s_nop 0
    buffer_load_dwordx4 v1, s[24:27], s47 offen lds
    buffer_load_dwordx4 v1, s[24:27], s47 offen offset:1024 lds
    buffer_load_dwordx4 v1, s[24:27], s47 offen offset:2048 lds
    buffer_load_dwordx4 v1, s[24:27], s47 offen offset:3072 lds
    s_add_u32 s56, s56, 4096
    s_and_b32 s56, s56, 0xffff
    s_add_u32 s47, s57, s56
    s_lshl_b32 s48, s56, 5
    s_add_u32 s49, s49, 24576
    s_cmp_ge_u32 s49, 147456
    s_cselect_b32 s49, 0, s49
    s_add_u32 m0, s49, s53
    s_nop 0
    buffer_load_dwordx4 v2, s[8:11], s48 offen lds
    s_add_u32 m0, m0, 1024
    s_nop 0
    buffer_load_dwordx4 v3, s[8:11], s48 offen lds
    s_add_u32 m0, s49, s54
    s_nop 0
    buffer_load_dwordx4 v1, s[24:27], s47 offen lds
    buffer_load_dwordx4 v1, s[24:27], s47 offen offset:1024 lds
    buffer_load_dwordx4 v1, s[24:27], s47 offen offset:2048 lds
    buffer_load_dwordx4 v1, s[24:27], s47 offen offset:3072 lds
    s_add_u32 s56, s56, 4096
    s_and_b32 s56, s56, 0xffff
    s_add_u32 s47, s57, s56
    s_lshl_b32 s48, s56, 5
    s_add_u32 s49, s49, 24576
    s_cmp_ge_u32 s49, 147456
    s_cselect_b32 s49, 0, s49
    s_add_u32 m0, s49, s53
    s_nop 0
    buffer_load_dwordx4 v2, s[8:11], s48 offen lds
    s_add_u32 m0, m0, 1024
    s_nop 0
    buffer_load_dwordx4 v3, s[8:11], s48 offen lds
    s_add_u32 m0, s49, s54
    s_nop 0
    buffer_load_dwordx4 v1, s[24:27], s47 offen lds
    buffer_load_dwordx4 v1, s[24:27], s47 offen offset:1024 lds
    buffer_load_dwordx4 v1, s[24:27], s47 offen offset:2048 lds
    buffer_load_dwordx4 v1, s[24:27], s47 offen offset:3072 lds
    s_add_u32 s56, s56, 4096
    s_and_b32 s56, s56, 0xffff
    s_add_u32 s47, s57, s56
    s_lshl_b32 s48, s56, 5
    s_add_u32 s49, s49, 24576
    s_cmp_ge_u32 s49, 147456
    s_cselect_b32 s49, 0, s49
    s_add_u32 m0, s49, s53
    s_nop 0
    buffer_load_dwordx4 v2, s[8:11], s48 offen lds
    s_add_u32 m0, m0, 1024
    s_nop 0
    buffer_load_dwordx4 v3, s[8:11], s48 offen lds
    s_add_u32 m0, s49, s54
    s_nop 0
    buffer_load_dwordx4 v1, s[24:27], s47 offen lds
    buffer_load_dwordx4 v1, s[24:27], s47 offen offset:1024 lds
    buffer_load_dwordx4 v1, s[24:27], s47 offen offset:2048 lds
    buffer_load_dwordx4 v1, s[24:27], s47 offen offset:3072 lds
    s_add_u32 s56, s56, 4096
    s_and_b32 s56, s56, 0xffff
    s_add_u32 s47, s57, s56
    s_lshl_b32 s48, s56, 5
    s_add_u32 s49, s49, 24576
    s_cmp_ge_u32 s49, 147456
    s_cselect_b32 s49, 0, s49
    s_add_u32 m0, s49, s53
    s_nop 0
    buffer_load_dwordx4 v2, s[8:11], s48 offen lds
    s_add_u32 m0, m0, 1024
    s_nop 0
    buffer_load_dwordx4 v3, s[8:11], s48 offen lds
    s_add_u32 m0, s49, s54
    s_nop 0
    buffer_load_dwordx4 v1, s[24:27], s47 offen lds
    buffer_load_dwordx4 v1, s[24:27], s47 offen offset:1024 lds
    buffer_load_dwordx4 v1, s[24:27], s47 offen offset:2048 lds
    buffer_load_dwordx4 v1, s[24:27], s47 offen offset:3072 lds
    s_add_u32 s56, s56, 4096
    s_and_b32 s56, s56, 0xffff
    s_add_u32 s47, s57, s56
    s_lshl_b32 s48, s56, 5
    s_add_u32 s49, s49, 24576
    s_cmp_ge_u32 s49, 147456
    s_cselect_b32 s49, 0, s49
    s_add_u32 m0, s49, s53
    s_nop 0
    buffer_load_dwordx4 v2, s[8:11], s48 offen lds
    s_add_u32 m0, m0, 1024
    s_nop 0
    buffer_load_dwordx4 v3, s[8:11], s48 offen lds
    s_add_u32 m0, s49, s54
    s_nop 0
    buffer_load_dwordx4 v1, s[24:27], s47 offen lds
    buffer_load_dwordx4 v1, s[24:27], s47 offen offset:1024 lds
    buffer_load_dwordx4 v1, s[24:27], s47 offen offset:2048 lds
    buffer_load_dwordx4 v1, s[24:27], s47 offen offset:3072 lds
    s_add_u32 s56, s56, 4096
    s_and_b32 s56, s56, 0xffff
    s_add_u32 s47, s57, s56
    s_lshl_b32 s48, s56, 5
    s_add_u32 s49, s49, 24576
    s_cmp_ge_u32 s49, 147456
    s_cselect_b32 s49, 0, s49
    v_mov_b32 v64, 0
    v_mov_b32 v65, 0
    v_mov_b32 v66, 0
    v_mov_b32 v67, 0
    v_mov_b32 v68, 0
    v_mov_b32 v69, 0
    v_mov_b32 v70, 0
    v_mov_b32 v71, 0
    v_mov_b32 v72, 0
    v_mov_b32 v73, 0
    v_mov_b32 v74, 0
    v_mov_b32 v75, 0
    v_mov_b32 v76, 0
    v_mov_b32 v77, 0
    v_mov_b32 v78, 0
    v_mov_b32 v79, 0
    v_mov_b32 v80, 0
    v_mov_b32 v81, 0
    v_mov_b32 v82, 0
    v_mov_b32 v83, 0
    v_mov_b32 v84, 0
    v_mov_b32 v85, 0
    v_mov_b32 v86, 0
    v_mov_b32 v87, 0
    v_mov_b32 v88, 0
    v_mov_b32 v89, 0
    v_mov_b32 v90, 0
    v_mov_b32 v91, 0
    v_mov_b32 v92, 0
    v_mov_b32 v93, 0
    v_mov_b32 v94, 0
    v_mov_b32 v95, 0
    s_waitcnt vmcnt(30)
    s_barrier
    ds_read_b128 v[136:139], v7 offset:0
    ds_read_b64_tr_b16 v[128:129], v6 offset:0
    ds_read_b64_tr_b16 v[130:131], v6 offset:1024
    ds_read_b64_tr_b16 v[132:133], v11 offset:0
    ds_read_b64_tr_b16 v[134:135], v11 offset:1024
    ds_read_b128 v[148:151], v7 offset:1024
    ds_read_b64_tr_b16 v[140:141], v6 offset:2048
    ds_read_b64_tr_b16 v[142:143], v6 offset:3072
    ds_read_b64_tr_b16 v[144:145], v11 offset:2048
    ds_read_b64_tr_b16 v[146:147], v11 offset:3072
    ds_read_b128 v[160:163], v7 offset:2048
    ds_read_b64_tr_b16 v[152:153], v6 offset:4096
    ds_read_b64_tr_b16 v[154:155], v6 offset:5120
    ds_read_b64_tr_b16 v[156:157], v11 offset:4096
    ds_read_b64_tr_b16 v[158:159], v11 offset:5120
    ds_read_b128 v[172:175], v7 offset:3072
    ds_read_b64_tr_b16 v[164:165], v6 offset:6144
    ds_read_b64_tr_b16 v[166:167], v6 offset:7168
    ds_read_b64_tr_b16 v[168:169], v11 offset:6144
    ds_read_b64_tr_b16 v[170:171], v11 offset:7168
    s_add_u32 s51, s51, 24576
    s_cmp_ge_u32 s51, 147456
    s_cselect_b32 s51, 0, s51
    v_add_u32 v6, s51, v4
    v_add_u32 v11, s51, v10
    v_add_u32 v7, s51, v5
    s_mov_b32 s52, 0
out_kernel_loop:
    s_waitcnt vmcnt(24) lgkmcnt(0)
    s_barrier
    v_mfma_f32_32x32x16_bf16 v[64:79], v[128:131], v[136:139], v[64:79]
    s_add_u32 m0, s49, s53
    ds_read_b128 v[184:187], v7 offset:0
    buffer_load_dwordx4 v2, s[8:11], s48 offen lds
    s_add_u32 m0, m0, 1024
    ds_read_b64_tr_b16 v[176:177], v6 offset:0
    buffer_load_dwordx4 v3, s[8:11], s48 offen lds
    v_mfma_f32_32x32x16_bf16 v[80:95], v[132:135], v[136:139], v[80:95]
    s_add_u32 m0, s49, s54
    ds_read_b64_tr_b16 v[178:179], v6 offset:1024
    buffer_load_dwordx4 v1, s[24:27], s47 offen lds
    ds_read_b64_tr_b16 v[180:181], v11 offset:0
    buffer_load_dwordx4 v1, s[24:27], s47 offen offset:1024 lds
    v_mfma_f32_32x32x16_bf16 v[64:79], v[140:143], v[148:151], v[64:79]
    ds_read_b64_tr_b16 v[182:183], v11 offset:1024
    buffer_load_dwordx4 v1, s[24:27], s47 offen offset:2048 lds
    ds_read_b128 v[196:199], v7 offset:1024
    buffer_load_dwordx4 v1, s[24:27], s47 offen offset:3072 lds
    ds_read_b64_tr_b16 v[188:189], v6 offset:2048
    v_mfma_f32_32x32x16_bf16 v[80:95], v[144:147], v[148:151], v[80:95]
    ds_read_b64_tr_b16 v[190:191], v6 offset:3072
    ds_read_b64_tr_b16 v[192:193], v11 offset:2048
    ds_read_b64_tr_b16 v[194:195], v11 offset:3072
    ds_read_b128 v[208:211], v7 offset:2048
    ds_read_b64_tr_b16 v[200:201], v6 offset:4096
    v_mfma_f32_32x32x16_bf16 v[64:79], v[152:155], v[160:163], v[64:79]
    ds_read_b64_tr_b16 v[202:203], v6 offset:5120
    ds_read_b64_tr_b16 v[204:205], v11 offset:4096
    ds_read_b64_tr_b16 v[206:207], v11 offset:5120
    ds_read_b128 v[220:223], v7 offset:3072
    ds_read_b64_tr_b16 v[212:213], v6 offset:6144
    ds_read_b64_tr_b16 v[214:215], v6 offset:7168
    v_mfma_f32_32x32x16_bf16 v[80:95], v[156:159], v[160:163], v[80:95]
    ds_read_b64_tr_b16 v[216:217], v11 offset:6144
    ds_read_b64_tr_b16 v[218:219], v11 offset:7168
    s_add_u32 s56, s56, 4096
    s_and_b32 s56, s56, 0xffff
    s_add_u32 s47, s57, s56
    v_mfma_f32_32x32x16_bf16 v[64:79], v[164:167], v[172:175], v[64:79]
    s_lshl_b32 s48, s56, 5
    s_add_u32 s49, s49, 24576
    s_cmp_ge_u32 s49, 147456
    s_cselect_b32 s49, 0, s49
    s_add_u32 s51, s51, 24576
    v_mfma_f32_32x32x16_bf16 v[80:95], v[168:171], v[172:175], v[80:95]
    s_cmp_ge_u32 s51, 147456
    s_cselect_b32 s51, 0, s51
    v_add_u32 v6, s51, v4
    v_add_u32 v11, s51, v10
    v_add_u32 v7, s51, v5
    s_waitcnt vmcnt(24) lgkmcnt(0)
    s_barrier
    v_mfma_f32_32x32x16_bf16 v[64:79], v[176:179], v[184:187], v[64:79]
    s_add_u32 m0, s49, s53
    ds_read_b128 v[136:139], v7 offset:0
    buffer_load_dwordx4 v2, s[8:11], s48 offen lds
    s_add_u32 m0, m0, 1024
    ds_read_b64_tr_b16 v[128:129], v6 offset:0
    buffer_load_dwordx4 v3, s[8:11], s48 offen lds
    v_mfma_f32_32x32x16_bf16 v[80:95], v[180:183], v[184:187], v[80:95]
    s_add_u32 m0, s49, s54
    ds_read_b64_tr_b16 v[130:131], v6 offset:1024
    buffer_load_dwordx4 v1, s[24:27], s47 offen lds
    ds_read_b64_tr_b16 v[132:133], v11 offset:0
    buffer_load_dwordx4 v1, s[24:27], s47 offen offset:1024 lds
    v_mfma_f32_32x32x16_bf16 v[64:79], v[188:191], v[196:199], v[64:79]
    ds_read_b64_tr_b16 v[134:135], v11 offset:1024
    buffer_load_dwordx4 v1, s[24:27], s47 offen offset:2048 lds
    ds_read_b128 v[148:151], v7 offset:1024
    buffer_load_dwordx4 v1, s[24:27], s47 offen offset:3072 lds
    ds_read_b64_tr_b16 v[140:141], v6 offset:2048
    v_mfma_f32_32x32x16_bf16 v[80:95], v[192:195], v[196:199], v[80:95]
    ds_read_b64_tr_b16 v[142:143], v6 offset:3072
    ds_read_b64_tr_b16 v[144:145], v11 offset:2048
    ds_read_b64_tr_b16 v[146:147], v11 offset:3072
    ds_read_b128 v[160:163], v7 offset:2048
    ds_read_b64_tr_b16 v[152:153], v6 offset:4096
    v_mfma_f32_32x32x16_bf16 v[64:79], v[200:203], v[208:211], v[64:79]
    ds_read_b64_tr_b16 v[154:155], v6 offset:5120
    ds_read_b64_tr_b16 v[156:157], v11 offset:4096
    ds_read_b64_tr_b16 v[158:159], v11 offset:5120
    ds_read_b128 v[172:175], v7 offset:3072
    ds_read_b64_tr_b16 v[164:165], v6 offset:6144
    ds_read_b64_tr_b16 v[166:167], v6 offset:7168
    v_mfma_f32_32x32x16_bf16 v[80:95], v[204:207], v[208:211], v[80:95]
    ds_read_b64_tr_b16 v[168:169], v11 offset:6144
    ds_read_b64_tr_b16 v[170:171], v11 offset:7168
    s_add_u32 s56, s56, 4096
    s_and_b32 s56, s56, 0xffff
    s_add_u32 s47, s57, s56
    v_mfma_f32_32x32x16_bf16 v[64:79], v[212:215], v[220:223], v[64:79]
    s_lshl_b32 s48, s56, 5
    s_add_u32 s49, s49, 24576
    s_cmp_ge_u32 s49, 147456
    s_cselect_b32 s49, 0, s49
    s_add_u32 s51, s51, 24576
    v_mfma_f32_32x32x16_bf16 v[80:95], v[216:219], v[220:223], v[80:95]
    s_cmp_ge_u32 s51, 147456
    s_cselect_b32 s51, 0, s51
    v_add_u32 v6, s51, v4
    v_add_u32 v11, s51, v10
    v_add_u32 v7, s51, v5
    s_add_u32 s52, s52, 1
    s_cmp_lt_u32 s52, 5
    s_cbranch_scc1 out_kernel_loop
    s_waitcnt vmcnt(24) lgkmcnt(0)
    s_barrier
    s_lshl_b32 s46, s44, 18
    s_lshl_b32 s55, s43, 11
    s_add_u32 s46, s46, s55
    s_add_u32 s46, s46, 25165824
    s_add_u32 s55, s46, 0
    buffer_load_dwordx4 v[96:99], v1, s[24:27], s55 offen offset:0
    buffer_load_dwordx4 v[100:103], v1, s[24:27], s55 offen offset:1024
    s_add_u32 s55, s46, 4194304
    buffer_load_dwordx4 v[104:107], v1, s[24:27], s55 offen offset:0
    buffer_load_dwordx4 v[108:111], v1, s[24:27], s55 offen offset:1024
    s_add_u32 s55, s46, 131072
    buffer_load_dwordx4 v[112:115], v1, s[24:27], s55 offen offset:0
    buffer_load_dwordx4 v[116:119], v1, s[24:27], s55 offen offset:1024
    s_add_u32 s55, s46, 4325376
    buffer_load_dwordx4 v[120:123], v1, s[24:27], s55 offen offset:0
    buffer_load_dwordx4 v[124:127], v1, s[24:27], s55 offen offset:1024
    s_mov_b32 s55, 33554432
    buffer_load_dword v8, v17, s[24:27], s55 offen
    v_mfma_f32_32x32x16_bf16 v[64:79], v[128:131], v[136:139], v[64:79]
    ds_read_b128 v[184:187], v7 offset:0
    ds_read_b64_tr_b16 v[176:177], v6 offset:0
    ds_read_b64_tr_b16 v[178:179], v6 offset:1024
    ds_read_b64_tr_b16 v[180:181], v11 offset:0
    v_mfma_f32_32x32x16_bf16 v[80:95], v[132:135], v[136:139], v[80:95]
    ds_read_b64_tr_b16 v[182:183], v11 offset:1024
    ds_read_b128 v[196:199], v7 offset:1024
    ds_read_b64_tr_b16 v[188:189], v6 offset:2048
    v_mfma_f32_32x32x16_bf16 v[64:79], v[140:143], v[148:151], v[64:79]
    ds_read_b64_tr_b16 v[190:191], v6 offset:3072
    ds_read_b64_tr_b16 v[192:193], v11 offset:2048
    ds_read_b64_tr_b16 v[194:195], v11 offset:3072
    v_mfma_f32_32x32x16_bf16 v[80:95], v[144:147], v[148:151], v[80:95]
    ds_read_b128 v[208:211], v7 offset:2048
    ds_read_b64_tr_b16 v[200:201], v6 offset:4096
    ds_read_b64_tr_b16 v[202:203], v6 offset:5120
    v_mfma_f32_32x32x16_bf16 v[64:79], v[152:155], v[160:163], v[64:79]
    ds_read_b64_tr_b16 v[204:205], v11 offset:4096
    ds_read_b64_tr_b16 v[206:207], v11 offset:5120
    ds_read_b128 v[220:223], v7 offset:3072
    ds_read_b64_tr_b16 v[212:213], v6 offset:6144
    v_mfma_f32_32x32x16_bf16 v[80:95], v[156:159], v[160:163], v[80:95]
    ds_read_b64_tr_b16 v[214:215], v6 offset:7168
    ds_read_b64_tr_b16 v[216:217], v11 offset:6144
    ds_read_b64_tr_b16 v[218:219], v11 offset:7168
    v_mfma_f32_32x32x16_bf16 v[64:79], v[164:167], v[172:175], v[64:79]
    s_add_u32 s51, s51, 24576
    s_cmp_ge_u32 s51, 147456
    s_cselect_b32 s51, 0, s51
    v_mfma_f32_32x32x16_bf16 v[80:95], v[168:171], v[172:175], v[80:95]
    v_add_u32 v6, s51, v4
    v_add_u32 v11, s51, v10
    v_add_u32 v7, s51, v5
    s_waitcnt vmcnt(27) lgkmcnt(0)
    s_barrier
    v_mfma_f32_32x32x16_bf16 v[64:79], v[176:179], v[184:187], v[64:79]
    ds_read_b128 v[136:139], v7 offset:0
    ds_read_b64_tr_b16 v[128:129], v6 offset:0
    ds_read_b64_tr_b16 v[130:131], v6 offset:1024
    ds_read_b64_tr_b16 v[132:133], v11 offset:0
    v_mfma_f32_32x32x16_bf16 v[80:95], v[180:183], v[184:187], v[80:95]
    ds_read_b64_tr_b16 v[134:135], v11 offset:1024
    ds_read_b128 v[148:151], v7 offset:1024
    ds_read_b64_tr_b16 v[140:141], v6 offset:2048
    v_mfma_f32_32x32x16_bf16 v[64:79], v[188:191], v[196:199], v[64:79]
    ds_read_b64_tr_b16 v[142:143], v6 offset:3072
    ds_read_b64_tr_b16 v[144:145], v11 offset:2048
    ds_read_b64_tr_b16 v[146:147], v11 offset:3072
    v_mfma_f32_32x32x16_bf16 v[80:95], v[192:195], v[196:199], v[80:95]
    ds_read_b128 v[160:163], v7 offset:2048
    ds_read_b64_tr_b16 v[152:153], v6 offset:4096
    ds_read_b64_tr_b16 v[154:155], v6 offset:5120
    v_mfma_f32_32x32x16_bf16 v[64:79], v[200:203], v[208:211], v[64:79]
    ds_read_b64_tr_b16 v[156:157], v11 offset:4096
    ds_read_b64_tr_b16 v[158:159], v11 offset:5120
    ds_read_b128 v[172:175], v7 offset:3072
    ds_read_b64_tr_b16 v[164:165], v6 offset:6144
    v_mfma_f32_32x32x16_bf16 v[80:95], v[204:207], v[208:211], v[80:95]
    ds_read_b64_tr_b16 v[166:167], v6 offset:7168
    ds_read_b64_tr_b16 v[168:169], v11 offset:6144
    ds_read_b64_tr_b16 v[170:171], v11 offset:7168
    v_mfma_f32_32x32x16_bf16 v[64:79], v[212:215], v[220:223], v[64:79]
    s_add_u32 s51, s51, 24576
    s_cmp_ge_u32 s51, 147456
    s_cselect_b32 s51, 0, s51
    v_mfma_f32_32x32x16_bf16 v[80:95], v[216:219], v[220:223], v[80:95]
    v_add_u32 v6, s51, v4
    v_add_u32 v11, s51, v10
    v_add_u32 v7, s51, v5
    s_waitcnt vmcnt(21) lgkmcnt(0)
    s_barrier
    v_mfma_f32_32x32x16_bf16 v[64:79], v[128:131], v[136:139], v[64:79]
    ds_read_b128 v[184:187], v7 offset:0
    ds_read_b64_tr_b16 v[176:177], v6 offset:0
    ds_read_b64_tr_b16 v[178:179], v6 offset:1024
    ds_read_b64_tr_b16 v[180:181], v11 offset:0
    v_mfma_f32_32x32x16_bf16 v[80:95], v[132:135], v[136:139], v[80:95]
    ds_read_b64_tr_b16 v[182:183], v11 offset:1024
    ds_read_b128 v[196:199], v7 offset:1024
    ds_read_b64_tr_b16 v[188:189], v6 offset:2048
    v_mfma_f32_32x32x16_bf16 v[64:79], v[140:143], v[148:151], v[64:79]
    ds_read_b64_tr_b16 v[190:191], v6 offset:3072
    ds_read_b64_tr_b16 v[192:193], v11 offset:2048
    ds_read_b64_tr_b16 v[194:195], v11 offset:3072
    v_mfma_f32_32x32x16_bf16 v[80:95], v[144:147], v[148:151], v[80:95]
    ds_read_b128 v[208:211], v7 offset:2048
    ds_read_b64_tr_b16 v[200:201], v6 offset:4096
    ds_read_b64_tr_b16 v[202:203], v6 offset:5120
    v_mfma_f32_32x32x16_bf16 v[64:79], v[152:155], v[160:163], v[64:79]
    ds_read_b64_tr_b16 v[204:205], v11 offset:4096
    ds_read_b64_tr_b16 v[206:207], v11 offset:5120
    ds_read_b128 v[220:223], v7 offset:3072
    ds_read_b64_tr_b16 v[212:213], v6 offset:6144
    v_mfma_f32_32x32x16_bf16 v[80:95], v[156:159], v[160:163], v[80:95]
    ds_read_b64_tr_b16 v[214:215], v6 offset:7168
    ds_read_b64_tr_b16 v[216:217], v11 offset:6144
    ds_read_b64_tr_b16 v[218:219], v11 offset:7168
    v_mfma_f32_32x32x16_bf16 v[64:79], v[164:167], v[172:175], v[64:79]
    s_add_u32 s51, s51, 24576
    s_cmp_ge_u32 s51, 147456
    s_cselect_b32 s51, 0, s51
    v_mfma_f32_32x32x16_bf16 v[80:95], v[168:171], v[172:175], v[80:95]
    v_add_u32 v6, s51, v4
    v_add_u32 v11, s51, v10
    v_add_u32 v7, s51, v5
    s_waitcnt vmcnt(15) lgkmcnt(0)
    s_barrier
    v_mfma_f32_32x32x16_bf16 v[64:79], v[176:179], v[184:187], v[64:79]
    ds_read_b128 v[136:139], v7 offset:0
    ds_read_b64_tr_b16 v[128:129], v6 offset:0
    ds_read_b64_tr_b16 v[130:131], v6 offset:1024
    ds_read_b64_tr_b16 v[132:133], v11 offset:0
    v_mfma_f32_32x32x16_bf16 v[80:95], v[180:183], v[184:187], v[80:95]
    ds_read_b64_tr_b16 v[134:135], v11 offset:1024
    ds_read_b128 v[148:151], v7 offset:1024
    ds_read_b64_tr_b16 v[140:141], v6 offset:2048
    v_mfma_f32_32x32x16_bf16 v[64:79], v[188:191], v[196:199], v[64:79]
    ds_read_b64_tr_b16 v[142:143], v6 offset:3072
    ds_read_b64_tr_b16 v[144:145], v11 offset:2048
    ds_read_b64_tr_b16 v[146:147], v11 offset:3072
    v_mfma_f32_32x32x16_bf16 v[80:95], v[192:195], v[196:199], v[80:95]
    ds_read_b128 v[160:163], v7 offset:2048
    ds_read_b64_tr_b16 v[152:153], v6 offset:4096
    ds_read_b64_tr_b16 v[154:155], v6 offset:5120
    v_mfma_f32_32x32x16_bf16 v[64:79], v[200:203], v[208:211], v[64:79]
    ds_read_b64_tr_b16 v[156:157], v11 offset:4096
    ds_read_b64_tr_b16 v[158:159], v11 offset:5120
    ds_read_b128 v[172:175], v7 offset:3072
    ds_read_b64_tr_b16 v[164:165], v6 offset:6144
    v_mfma_f32_32x32x16_bf16 v[80:95], v[204:207], v[208:211], v[80:95]
    ds_read_b64_tr_b16 v[166:167], v6 offset:7168
    ds_read_b64_tr_b16 v[168:169], v11 offset:6144
    ds_read_b64_tr_b16 v[170:171], v11 offset:7168
    v_mfma_f32_32x32x16_bf16 v[64:79], v[212:215], v[220:223], v[64:79]
    s_add_u32 s51, s51, 24576
    s_cmp_ge_u32 s51, 147456
    s_cselect_b32 s51, 0, s51
    v_mfma_f32_32x32x16_bf16 v[80:95], v[216:219], v[220:223], v[80:95]
    v_add_u32 v6, s51, v4
    v_add_u32 v11, s51, v10
    v_add_u32 v7, s51, v5
    s_waitcnt vmcnt(9) lgkmcnt(0)
    s_barrier
    v_mfma_f32_32x32x16_bf16 v[64:79], v[128:131], v[136:139], v[64:79]
    ds_read_b128 v[184:187], v7 offset:0
    ds_read_b64_tr_b16 v[176:177], v6 offset:0
    ds_read_b64_tr_b16 v[178:179], v6 offset:1024
    ds_read_b64_tr_b16 v[180:181], v11 offset:0
    v_mfma_f32_32x32x16_bf16 v[80:95], v[132:135], v[136:139], v[80:95]
    ds_read_b64_tr_b16 v[182:183], v11 offset:1024
    ds_read_b128 v[196:199], v7 offset:1024
    ds_read_b64_tr_b16 v[188:189], v6 offset:2048
    v_mfma_f32_32x32x16_bf16 v[64:79], v[140:143], v[148:151], v[64:79]
    ds_read_b64_tr_b16 v[190:191], v6 offset:3072
    ds_read_b64_tr_b16 v[192:193], v11 offset:2048
    ds_read_b64_tr_b16 v[194:195], v11 offset:3072
    v_mfma_f32_32x32x16_bf16 v[80:95], v[144:147], v[148:151], v[80:95]
    ds_read_b128 v[208:211], v7 offset:2048
    ds_read_b64_tr_b16 v[200:201], v6 offset:4096
    ds_read_b64_tr_b16 v[202:203], v6 offset:5120
    v_mfma_f32_32x32x16_bf16 v[64:79], v[152:155], v[160:163], v[64:79]
    ds_read_b64_tr_b16 v[204:205], v11 offset:4096
    ds_read_b64_tr_b16 v[206:207], v11 offset:5120
    ds_read_b128 v[220:223], v7 offset:3072
    ds_read_b64_tr_b16 v[212:213], v6 offset:6144
    v_mfma_f32_32x32x16_bf16 v[80:95], v[156:159], v[160:163], v[80:95]
    ds_read_b64_tr_b16 v[214:215], v6 offset:7168
    ds_read_b64_tr_b16 v[216:217], v11 offset:6144
    ds_read_b64_tr_b16 v[218:219], v11 offset:7168
    v_mfma_f32_32x32x16_bf16 v[64:79], v[164:167], v[172:175], v[64:79]
    s_add_u32 s51, s51, 24576
    s_cmp_ge_u32 s51, 147456
    s_cselect_b32 s51, 0, s51
    v_mfma_f32_32x32x16_bf16 v[80:95], v[168:171], v[172:175], v[80:95]
    v_add_u32 v6, s51, v4
    v_add_u32 v11, s51, v10
    v_add_u32 v7, s51, v5
    s_waitcnt vmcnt(9) lgkmcnt(0)
    v_mfma_f32_32x32x16_bf16 v[64:79], v[176:179], v[184:187], v[64:79]
    v_mfma_f32_32x32x16_bf16 v[80:95], v[180:183], v[184:187], v[80:95]
    v_mfma_f32_32x32x16_bf16 v[64:79], v[188:191], v[196:199], v[64:79]
    v_mfma_f32_32x32x16_bf16 v[80:95], v[192:195], v[196:199], v[80:95]
    v_mfma_f32_32x32x16_bf16 v[64:79], v[200:203], v[208:211], v[64:79]
    v_mfma_f32_32x32x16_bf16 v[80:95], v[204:207], v[208:211], v[80:95]
    v_mfma_f32_32x32x16_bf16 v[64:79], v[212:215], v[220:223], v[64:79]
    v_mfma_f32_32x32x16_bf16 v[80:95], v[216:219], v[220:223], v[80:95]
    s_nop 15
    s_waitcnt vmcnt(0)
    v_sub_f32 v20, 1.0, v8
    v_cvt_pk_bf16_f32 v20, v20, v20
    v_lshlrev_b32 v20, 16, v20
    v_mul_f32 v64, v20, v64
    v_mul_f32 v65, v20, v65
    v_mul_f32 v66, v20, v66
    v_mul_f32 v67, v20, v67
    v_mul_f32 v68, v20, v68
    v_mul_f32 v69, v20, v69
    v_mul_f32 v70, v20, v70
    v_mul_f32 v71, v20, v71
    v_mul_f32 v72, v20, v72
    v_mul_f32 v73, v20, v73
    v_mul_f32 v74, v20, v74
    v_mul_f32 v75, v20, v75
    v_mul_f32 v76, v20, v76
    v_mul_f32 v77, v20, v77
    v_mul_f32 v78, v20, v78
    v_mul_f32 v79, v20, v79
    v_lshlrev_b32 v16, 16, v96
    v_lshlrev_b32 v17, 16, v104
    v_sub_f32 v16, v16, v17
    v_and_b32 v18, 0xffff0000, v96
    v_and_b32 v19, 0xffff0000, v104
    v_sub_f32 v18, v18, v19
    v_fmac_f32 v64, v8, v16
    v_fmac_f32 v65, v8, v18
    v_cvt_pk_bf16_f32 v32, v64, v65
    v_lshlrev_b32 v16, 16, v97
    v_lshlrev_b32 v17, 16, v105
    v_sub_f32 v16, v16, v17
    v_and_b32 v18, 0xffff0000, v97
    v_and_b32 v19, 0xffff0000, v105
    v_sub_f32 v18, v18, v19
    v_fmac_f32 v66, v8, v16
    v_fmac_f32 v67, v8, v18
    v_cvt_pk_bf16_f32 v33, v66, v67
    v_lshlrev_b32 v16, 16, v98
    v_lshlrev_b32 v17, 16, v106
    v_sub_f32 v16, v16, v17
    v_and_b32 v18, 0xffff0000, v98
    v_and_b32 v19, 0xffff0000, v106
    v_sub_f32 v18, v18, v19
    v_fmac_f32 v68, v8, v16
    v_fmac_f32 v69, v8, v18
    v_cvt_pk_bf16_f32 v34, v68, v69
    v_lshlrev_b32 v16, 16, v99
    v_lshlrev_b32 v17, 16, v107
    v_sub_f32 v16, v16, v17
    v_and_b32 v18, 0xffff0000, v99
    v_and_b32 v19, 0xffff0000, v107
    v_sub_f32 v18, v18, v19
    v_fmac_f32 v70, v8, v16
    v_fmac_f32 v71, v8, v18
    v_cvt_pk_bf16_f32 v35, v70, v71
    v_lshlrev_b32 v16, 16, v100
    v_lshlrev_b32 v17, 16, v108
    v_sub_f32 v16, v16, v17
    v_and_b32 v18, 0xffff0000, v100
    v_and_b32 v19, 0xffff0000, v108
    v_sub_f32 v18, v18, v19
    v_fmac_f32 v72, v8, v16
    v_fmac_f32 v73, v8, v18
    v_cvt_pk_bf16_f32 v36, v72, v73
    v_lshlrev_b32 v16, 16, v101
    v_lshlrev_b32 v17, 16, v109
    v_sub_f32 v16, v16, v17
    v_and_b32 v18, 0xffff0000, v101
    v_and_b32 v19, 0xffff0000, v109
    v_sub_f32 v18, v18, v19
    v_fmac_f32 v74, v8, v16
    v_fmac_f32 v75, v8, v18
    v_cvt_pk_bf16_f32 v37, v74, v75
    v_lshlrev_b32 v16, 16, v102
    v_lshlrev_b32 v17, 16, v110
    v_sub_f32 v16, v16, v17
    v_and_b32 v18, 0xffff0000, v102
    v_and_b32 v19, 0xffff0000, v110
    v_sub_f32 v18, v18, v19
    v_fmac_f32 v76, v8, v16
    v_fmac_f32 v77, v8, v18
    v_cvt_pk_bf16_f32 v38, v76, v77
    v_lshlrev_b32 v16, 16, v103
    v_lshlrev_b32 v17, 16, v111
    v_sub_f32 v16, v16, v17
    v_and_b32 v18, 0xffff0000, v103
    v_and_b32 v19, 0xffff0000, v111
    v_sub_f32 v18, v18, v19
    v_fmac_f32 v78, v8, v16
    v_fmac_f32 v79, v8, v18
    v_cvt_pk_bf16_f32 v39, v78, v79
    s_nop 1
    v_permlane32_swap_b32 v32, v34
    v_permlane32_swap_b32 v33, v35
    v_permlane32_swap_b32 v36, v38
    v_permlane32_swap_b32 v37, v39
    buffer_store_dwordx4 v[32:35], v9, s[12:15], 0 offen offset:0 nt
    buffer_store_dwordx4 v[36:39], v9, s[12:15], 0 offen offset:32 nt
    v_mul_f32 v80, v20, v80
    v_mul_f32 v81, v20, v81
    v_mul_f32 v82, v20, v82
    v_mul_f32 v83, v20, v83
    v_mul_f32 v84, v20, v84
    v_mul_f32 v85, v20, v85
    v_mul_f32 v86, v20, v86
    v_mul_f32 v87, v20, v87
    v_mul_f32 v88, v20, v88
    v_mul_f32 v89, v20, v89
    v_mul_f32 v90, v20, v90
    v_mul_f32 v91, v20, v91
    v_mul_f32 v92, v20, v92
    v_mul_f32 v93, v20, v93
    v_mul_f32 v94, v20, v94
    v_mul_f32 v95, v20, v95
    v_lshlrev_b32 v16, 16, v112
    v_lshlrev_b32 v17, 16, v120
    v_sub_f32 v16, v16, v17
    v_and_b32 v18, 0xffff0000, v112
    v_and_b32 v19, 0xffff0000, v120
    v_sub_f32 v18, v18, v19
    v_fmac_f32 v80, v8, v16
    v_fmac_f32 v81, v8, v18
    v_cvt_pk_bf16_f32 v40, v80, v81
    v_lshlrev_b32 v16, 16, v113
    v_lshlrev_b32 v17, 16, v121
    v_sub_f32 v16, v16, v17
    v_and_b32 v18, 0xffff0000, v113
    v_and_b32 v19, 0xffff0000, v121
    v_sub_f32 v18, v18, v19
    v_fmac_f32 v82, v8, v16
    v_fmac_f32 v83, v8, v18
    v_cvt_pk_bf16_f32 v41, v82, v83
    v_lshlrev_b32 v16, 16, v114
    v_lshlrev_b32 v17, 16, v122
    v_sub_f32 v16, v16, v17
    v_and_b32 v18, 0xffff0000, v114
    v_and_b32 v19, 0xffff0000, v122
    v_sub_f32 v18, v18, v19
    v_fmac_f32 v84, v8, v16
    v_fmac_f32 v85, v8, v18
    v_cvt_pk_bf16_f32 v42, v84, v85
    v_lshlrev_b32 v16, 16, v115
    v_lshlrev_b32 v17, 16, v123
    v_sub_f32 v16, v16, v17
    v_and_b32 v18, 0xffff0000, v115
    v_and_b32 v19, 0xffff0000, v123
    v_sub_f32 v18, v18, v19
    v_fmac_f32 v86, v8, v16
    v_fmac_f32 v87, v8, v18
    v_cvt_pk_bf16_f32 v43, v86, v87
    v_lshlrev_b32 v16, 16, v116
    v_lshlrev_b32 v17, 16, v124
    v_sub_f32 v16, v16, v17
    v_and_b32 v18, 0xffff0000, v116
    v_and_b32 v19, 0xffff0000, v124
    v_sub_f32 v18, v18, v19
    v_fmac_f32 v88, v8, v16
    v_fmac_f32 v89, v8, v18
    v_cvt_pk_bf16_f32 v44, v88, v89
    v_lshlrev_b32 v16, 16, v117
    v_lshlrev_b32 v17, 16, v125
    v_sub_f32 v16, v16, v17
    v_and_b32 v18, 0xffff0000, v117
    v_and_b32 v19, 0xffff0000, v125
    v_sub_f32 v18, v18, v19
    v_fmac_f32 v90, v8, v16
    v_fmac_f32 v91, v8, v18
    v_cvt_pk_bf16_f32 v45, v90, v91
    v_lshlrev_b32 v16, 16, v118
    v_lshlrev_b32 v17, 16, v126
    v_sub_f32 v16, v16, v17
    v_and_b32 v18, 0xffff0000, v118
    v_and_b32 v19, 0xffff0000, v126
    v_sub_f32 v18, v18, v19
    v_fmac_f32 v92, v8, v16
    v_fmac_f32 v93, v8, v18
    v_cvt_pk_bf16_f32 v46, v92, v93
    v_lshlrev_b32 v16, 16, v119
    v_lshlrev_b32 v17, 16, v127
    v_sub_f32 v16, v16, v17
    v_and_b32 v18, 0xffff0000, v119
    v_and_b32 v19, 0xffff0000, v127
    v_sub_f32 v18, v18, v19
    v_fmac_f32 v94, v8, v16
    v_fmac_f32 v95, v8, v18
    v_cvt_pk_bf16_f32 v47, v94, v95
    s_nop 1
    v_permlane32_swap_b32 v40, v42
    v_permlane32_swap_b32 v41, v43
    v_permlane32_swap_b32 v44, v46
    v_permlane32_swap_b32 v45, v47
    buffer_store_dwordx4 v[40:43], v9, s[12:15], 0 offen offset:64 nt
    buffer_store_dwordx4 v[44:47], v9, s[12:15], 0 offen offset:96 nt
out_kernel_done:
    s_endpgm
.section .rodata,"a"

.p2align 6
.amdhsa_kernel proj_kernel
  .amdhsa_next_free_vgpr 256
  .amdhsa_next_free_sgpr 102
  .amdhsa_accum_offset 256
  .amdhsa_group_segment_fixed_size 0
  .amdhsa_kernarg_size 96
  .amdhsa_user_sgpr_count 2
  .amdhsa_user_sgpr_kernarg_segment_ptr 1
  .amdhsa_system_sgpr_workgroup_id_x 1
.end_amdhsa_kernel

.p2align 6
.amdhsa_kernel mix_kernel
  .amdhsa_next_free_vgpr 216
  .amdhsa_next_free_sgpr 102
  .amdhsa_accum_offset 216
  .amdhsa_group_segment_fixed_size 0
  .amdhsa_kernarg_size 96
  .amdhsa_user_sgpr_count 2
  .amdhsa_user_sgpr_kernarg_segment_ptr 1
  .amdhsa_system_sgpr_workgroup_id_x 1
.end_amdhsa_kernel

.p2align 6
.amdhsa_kernel out_kernel
  .amdhsa_next_free_vgpr 224
  .amdhsa_next_free_sgpr 102
  .amdhsa_accum_offset 224
  .amdhsa_group_segment_fixed_size 0
  .amdhsa_kernarg_size 96
  .amdhsa_user_sgpr_count 2
  .amdhsa_user_sgpr_kernarg_segment_ptr 1
  .amdhsa_system_sgpr_workgroup_id_x 1
.end_amdhsa_kernel
```
